```python
import torch

def _softmax(x, axis=-1):
    return torch.softmax(x, dim=axis)
def _gelu(x):
    return torch.nn.functional.gelu(x, approximate="tanh")
def _silu(x):
    return torch.nn.functional.silu(x)
def _sigmoid(x):
    return torch.sigmoid(x)
def _layernorm(x, axis=-1, eps=1e-5):
    m = x.mean(dim=axis, keepdim=True)
    v = x.var(dim=axis, keepdim=True, unbiased=False)
    return (x - m) / torch.sqrt(v + eps)
def _scatter_add(tgt, idx, src, axis=0):
    return tgt.clone().index_add_(axis, idx, src)
def _segment_sum(src, seg, n):
    out = torch.zeros((n,) + src.shape[1:], dtype=src.dtype)
    return out.index_add_(0, seg, src)
def _pad(x, pw):
    flat = tuple(v for pair in reversed(pw) for v in pair)
    return torch.nn.functional.pad(x, flat)

kernel_name = 'sequential_preLN__spectral_fnet__geglu_ffn__prompt'

def setup_inputs():

    _w = (lambda a: (lambda t: t.to(torch.bfloat16) if t.is_floating_point() else t)(torch.as_tensor(a)))
    def _A_setup():
        B, S, D = 1, 2048, 512
        ns = torch.arange(S)[:, None] * torch.arange(S)[None, :]
        nd = torch.arange(D)[:, None] * torch.arange(D)[None, :]
        Ws_re = torch.cos(-2.0 * torch.pi * ns / S).to(float)
        Ws_im = torch.sin(-2.0 * torch.pi * ns / S).to(float)
        Wd_re = torch.cos(-2.0 * torch.pi * nd / D).to(float)
        Wd_im = torch.sin(-2.0 * torch.pi * nd / D).to(float)
        return {
            "x": _w((lambda *s: torch.randn(*s, dtype=torch.bfloat16) * 0.05)(B, S, D)),
            "dft_seq_re": _w(Ws_re),
            "dft_seq_im": _w(Ws_im),
            "dft_hid_re": _w(Wd_re),
            "dft_hid_im": _w(Wd_im),
        }
    _A_in = _A_setup()

    def _B_setup():
        B, S, D, F = 1, 2048, 512, 1792
        return {
            "x": _w((lambda *s: torch.randn(*s, dtype=torch.bfloat16) * 0.05)(B, S, D)),
            "w_gate": _w((lambda *s: torch.randn(*s, dtype=torch.bfloat16) * 0.2)(D, F)),
            "w_up": _w((lambda *s: torch.randn(*s, dtype=torch.bfloat16) * 0.2)(D, F)),
            "w_down": _w((lambda *s: torch.randn(*s, dtype=torch.bfloat16) * 0.2)(F, D)),
        }
    _B_in = _B_setup()

    return {
        "A_x": _A_in["x"],
        "A_dft_seq_re": _A_in["dft_seq_re"],
        "A_dft_seq_im": _A_in["dft_seq_im"],
        "A_dft_hid_re": _A_in["dft_hid_re"],
        "A_dft_hid_im": _A_in["dft_hid_im"],
        "B_x": _B_in["x"],
        "B_w_gate": _B_in["w_gate"],
        "B_w_up": _B_in["w_up"],
        "B_w_down": _B_in["w_down"],
    }

def reference(A_x, A_dft_seq_re, A_dft_seq_im, A_dft_hid_re, A_dft_hid_im, B_x, B_w_gate, B_w_up, B_w_down):
    def _A_ref(x, dft_seq_re, dft_seq_im, dft_hid_re, dft_hid_im):
        a = torch.einsum("bsd,ed->bse", x, dft_hid_re)
        b = torch.einsum("bsd,ed->bse", x, dft_hid_im)
        y = torch.einsum("ts,bse->bte", dft_seq_re, a) - torch.einsum("ts,bse->bte", dft_seq_im, b)
        return y

    def _B_ref(x, w_gate, w_up, w_down):
        return (_gelu(x @ w_gate) * (x @ w_up)) @ w_down

    x = A_x
    h = x + _A_ref(_layernorm(x, axis=-1), A_dft_seq_re, A_dft_seq_im, A_dft_hid_re, A_dft_hid_im)
    h2 = h + _B_ref(_layernorm(h, axis=-1), B_w_gate, B_w_up, B_w_down)
    return h2
```

```asm
; @launch grid=(256,1,1) block=(256,1,1) lds=163840
.amdgcn_target "amdgcn-amd-amdhsa--gfx950"
.text
.globl sequential_preLN__spectral_fnet__geglu_ffn__prompt_kernel
.p2align 8
.type sequential_preLN__spectral_fnet__geglu_ffn__prompt_kernel,@function
sequential_preLN__spectral_fnet__geglu_ffn__prompt_kernel:
    s_cmp_ge_u32 s2, 256
    s_cbranch_scc1 L_end
    s_load_dwordx2 s[8:9], s[0:1], 0
    s_load_dwordx4 s[28:31], s[0:1], 80
    s_load_dwordx4 s[32:35], s[0:1], 48
    s_load_dwordx4 s[40:43], s[0:1], 64
    v_lshrrev_b32 v1, 6, v0
    v_and_b32 v2, 63, v0
    v_readfirstlane_b32 s16, v1
    v_and_b32 v3, 15, v2
    v_lshrrev_b32 v4, 4, v2
    v_lshlrev_b32 v253, 4, v2
    s_lshr_b32 s3, s2, 3
    s_and_b32 s17, s3, 3
    s_lshr_b32 s3, s3, 2
    s_lshl_b32 s3, s3, 3
    s_and_b32 s4, s2, 7
    s_add_u32 s18, s3, s4
    s_lshl_b32 s3, s16, 3
    s_lshl_b32 s4, s3, 16
    s_lshl_b32 s5, s18, 10
    s_add_u32 s4, s4, s5
    s_lshl_b32 s5, s3, 10
    s_add_u32 s5, s5, 131072
    s_and_b32 s6, s3, 15
    s_lshl_b32 s6, s6, 4
    v_xor_b32 v5, s6, v253
    s_waitcnt lgkmcnt(0)
    s_mov_b32 s10, 2097152
    s_mov_b32 s11, 0x20000
    s_mov_b32 s12, s30
    s_mov_b32 s13, s31
    s_mov_b32 s14, 268435456
    s_mov_b32 s15, 0x20000
    s_mov_b32 s30, 256
    s_mov_b32 s31, 0x20000
    s_mov_b32 s44, s42
    s_mov_b32 s45, s43
    s_mov_b32 s46, 2097152
    s_mov_b32 s47, 0x20000
    s_mov_b32 s42, 1835008
    s_mov_b32 s43, 0x20000
    s_mov_b32 s36, s34
    s_mov_b32 s37, s35
    s_mov_b32 s34, 1835008
    s_mov_b32 s35, 0x20000
    s_mov_b32 s38, 1835008
    s_mov_b32 s39, 0x20000
    s_or_b32 s22, s2, s16
    s_lshr_b32 s3, s2, 2
    s_or_b32 s3, s3, s16
    s_cmp_lg_u32 s3, 0
    s_cbranch_scc1 L_noreset
    v_mov_b32 v8, 0
    v_mov_b32 v9, 0
    v_mov_b32 v10, 0
    v_mov_b32 v11, 0
    s_lshl_b32 s3, s2, 13
    s_add_u32 s3, s3, 16777216
    s_add_u32 s7, s3, 4096
    buffer_store_dwordx4 v[8:11], v253, s[12:15], s3 offen offset:0 sc1
    buffer_store_dwordx4 v[8:11], v253, s[12:15], s3 offen offset:1024 sc1
    buffer_store_dwordx4 v[8:11], v253, s[12:15], s3 offen offset:2048 sc1
    buffer_store_dwordx4 v[8:11], v253, s[12:15], s3 offen offset:3072 sc1
    buffer_store_dwordx4 v[8:11], v253, s[12:15], s7 offen offset:0 sc1
    buffer_store_dwordx4 v[8:11], v253, s[12:15], s7 offen offset:1024 sc1
    buffer_store_dwordx4 v[8:11], v253, s[12:15], s7 offen offset:2048 sc1
    buffer_store_dwordx4 v[8:11], v253, s[12:15], s7 offen offset:3072 sc1
    L_noreset:
    v_xor_b32 v6, 0x0, v5
    s_mov_b32 m0, s5
    s_add_u32 s5, s5, 1024
    buffer_load_dwordx4 v6, s[8:11], s4 offen lds
    s_add_u32 s4, s4, 65536
    v_xor_b32 v6, 0x10, v5
    s_mov_b32 m0, s5
    s_add_u32 s5, s5, 1024
    buffer_load_dwordx4 v6, s[8:11], s4 offen lds
    s_add_u32 s4, s4, 65536
    v_xor_b32 v6, 0x20, v5
    s_mov_b32 m0, s5
    s_add_u32 s5, s5, 1024
    buffer_load_dwordx4 v6, s[8:11], s4 offen lds
    s_add_u32 s4, s4, 65536
    v_xor_b32 v6, 0x30, v5
    s_mov_b32 m0, s5
    s_add_u32 s5, s5, 1024
    buffer_load_dwordx4 v6, s[8:11], s4 offen lds
    s_add_u32 s4, s4, 65536
    v_xor_b32 v6, 0x40, v5
    s_mov_b32 m0, s5
    s_add_u32 s5, s5, 1024
    buffer_load_dwordx4 v6, s[8:11], s4 offen lds
    s_add_u32 s4, s4, 65536
    v_xor_b32 v6, 0x50, v5
    s_mov_b32 m0, s5
    s_add_u32 s5, s5, 1024
    buffer_load_dwordx4 v6, s[8:11], s4 offen lds
    s_add_u32 s4, s4, 65536
    v_xor_b32 v6, 0x60, v5
    s_mov_b32 m0, s5
    s_add_u32 s5, s5, 1024
    buffer_load_dwordx4 v6, s[8:11], s4 offen lds
    s_add_u32 s4, s4, 65536
    v_xor_b32 v6, 0x70, v5
    s_mov_b32 m0, s5
    s_add_u32 s5, s5, 1024
    buffer_load_dwordx4 v6, s[8:11], s4 offen lds
    s_add_u32 s4, s4, 65536
    s_lshl_b32 s19, s17, 2
    s_add_u32 s19, s19, s16
    s_lshl_b32 s3, s19, 5
    s_cmp_lt_u32 s17, 2
    s_cselect_b32 s4, 1, -254
    s_cselect_b32 s20, -1.0, 1.0
    s_add_u32 s3, s3, s4
    v_lshl_add_u32 v7, v3, 1, s3
    v_cvt_f32_u32 v5, v7
    v_mul_f32 v5, 0x3b000000, v5
    v_lshlrev_b32 v6, 3, v4
    v_cvt_f32_u32 v6, v6
    v_mul_f32 v6, v5, v6
    v_bfe_i32 v14, v7, 1, 1
    v_and_b32 v14, 0x80008000, v14
    v_xor_b32 v15, 0x80008000, v14
    v_mov_b32 v8, v6
    v_fmamk_f32 v9, v5, 0x3f800000, v6
    v_cos_f32 v10, v8
    v_cos_f32 v11, v9
    v_sin_f32 v12, -v8
    v_sin_f32 v13, -v9
    v_cvt_pk_bf16_f32 v16, v10, v11
    v_cvt_pk_bf16_f32 v48, v12, v13
    v_fmamk_f32 v8, v5, 0x40000000, v6
    v_fmamk_f32 v9, v5, 0x40400000, v6
    v_cos_f32 v10, v8
    v_cos_f32 v11, v9
    v_sin_f32 v12, -v8
    v_sin_f32 v13, -v9
    v_cvt_pk_bf16_f32 v17, v10, v11
    v_cvt_pk_bf16_f32 v49, v12, v13
    v_fmamk_f32 v8, v5, 0x40800000, v6
    v_fmamk_f32 v9, v5, 0x40a00000, v6
    v_cos_f32 v10, v8
    v_cos_f32 v11, v9
    v_sin_f32 v12, -v8
    v_sin_f32 v13, -v9
    v_cvt_pk_bf16_f32 v18, v10, v11
    v_cvt_pk_bf16_f32 v50, v12, v13
    v_fmamk_f32 v8, v5, 0x40c00000, v6
    v_fmamk_f32 v9, v5, 0x40e00000, v6
    v_cos_f32 v10, v8
    v_cos_f32 v11, v9
    v_sin_f32 v12, -v8
    v_sin_f32 v13, -v9
    v_cvt_pk_bf16_f32 v19, v10, v11
    v_cvt_pk_bf16_f32 v51, v12, v13
    v_fmamk_f32 v8, v5, 0x42000000, v6
    v_fmamk_f32 v9, v5, 0x42040000, v6
    v_cos_f32 v10, v8
    v_cos_f32 v11, v9
    v_sin_f32 v12, -v8
    v_sin_f32 v13, -v9
    v_cvt_pk_bf16_f32 v20, v10, v11
    v_cvt_pk_bf16_f32 v52, v12, v13
    v_fmamk_f32 v8, v5, 0x42080000, v6
    v_fmamk_f32 v9, v5, 0x420c0000, v6
    v_cos_f32 v10, v8
    v_cos_f32 v11, v9
    v_sin_f32 v12, -v8
    v_sin_f32 v13, -v9
    v_cvt_pk_bf16_f32 v21, v10, v11
    v_cvt_pk_bf16_f32 v53, v12, v13
    v_fmamk_f32 v8, v5, 0x42100000, v6
    v_fmamk_f32 v9, v5, 0x42140000, v6
    v_cos_f32 v10, v8
    v_cos_f32 v11, v9
    v_sin_f32 v12, -v8
    v_sin_f32 v13, -v9
    v_cvt_pk_bf16_f32 v22, v10, v11
    v_cvt_pk_bf16_f32 v54, v12, v13
    v_fmamk_f32 v8, v5, 0x42180000, v6
    v_fmamk_f32 v9, v5, 0x421c0000, v6
    v_cos_f32 v10, v8
    v_cos_f32 v11, v9
    v_sin_f32 v12, -v8
    v_sin_f32 v13, -v9
    v_cvt_pk_bf16_f32 v23, v10, v11
    v_cvt_pk_bf16_f32 v55, v12, v13
    v_fmamk_f32 v8, v5, 0x42800000, v6
    v_fmamk_f32 v9, v5, 0x42820000, v6
    v_cos_f32 v10, v8
    v_cos_f32 v11, v9
    v_sin_f32 v12, -v8
    v_sin_f32 v13, -v9
    v_cvt_pk_bf16_f32 v24, v10, v11
    v_cvt_pk_bf16_f32 v56, v12, v13
    v_fmamk_f32 v8, v5, 0x42840000, v6
    v_fmamk_f32 v9, v5, 0x42860000, v6
    v_cos_f32 v10, v8
    v_cos_f32 v11, v9
    v_sin_f32 v12, -v8
    v_sin_f32 v13, -v9
    v_cvt_pk_bf16_f32 v25, v10, v11
    v_cvt_pk_bf16_f32 v57, v12, v13
    v_fmamk_f32 v8, v5, 0x42880000, v6
    v_fmamk_f32 v9, v5, 0x428a0000, v6
    v_cos_f32 v10, v8
    v_cos_f32 v11, v9
    v_sin_f32 v12, -v8
    v_sin_f32 v13, -v9
    v_cvt_pk_bf16_f32 v26, v10, v11
    v_cvt_pk_bf16_f32 v58, v12, v13
    v_fmamk_f32 v8, v5, 0x428c0000, v6
    v_fmamk_f32 v9, v5, 0x428e0000, v6
    v_cos_f32 v10, v8
    v_cos_f32 v11, v9
    v_sin_f32 v12, -v8
    v_sin_f32 v13, -v9
    v_cvt_pk_bf16_f32 v27, v10, v11
    v_cvt_pk_bf16_f32 v59, v12, v13
    v_fmamk_f32 v8, v5, 0x42c00000, v6
    v_fmamk_f32 v9, v5, 0x42c20000, v6
    v_cos_f32 v10, v8
    v_cos_f32 v11, v9
    v_sin_f32 v12, -v8
    v_sin_f32 v13, -v9
    v_cvt_pk_bf16_f32 v28, v10, v11
    v_cvt_pk_bf16_f32 v60, v12, v13
    v_fmamk_f32 v8, v5, 0x42c40000, v6
    v_fmamk_f32 v9, v5, 0x42c60000, v6
    v_cos_f32 v10, v8
    v_cos_f32 v11, v9
    v_sin_f32 v12, -v8
    v_sin_f32 v13, -v9
    v_cvt_pk_bf16_f32 v29, v10, v11
    v_cvt_pk_bf16_f32 v61, v12, v13
    v_fmamk_f32 v8, v5, 0x42c80000, v6
    v_fmamk_f32 v9, v5, 0x42ca0000, v6
    v_cos_f32 v10, v8
    v_cos_f32 v11, v9
    v_sin_f32 v12, -v8
    v_sin_f32 v13, -v9
    v_cvt_pk_bf16_f32 v30, v10, v11
    v_cvt_pk_bf16_f32 v62, v12, v13
    v_fmamk_f32 v8, v5, 0x42cc0000, v6
    v_fmamk_f32 v9, v5, 0x42ce0000, v6
    v_cos_f32 v10, v8
    v_cos_f32 v11, v9
    v_sin_f32 v12, -v8
    v_sin_f32 v13, -v9
    v_cvt_pk_bf16_f32 v31, v10, v11
    v_cvt_pk_bf16_f32 v63, v12, v13
    s_cmp_lt_u32 s17, 2
    s_cbranch_scc1 L_odd
    v_xor_b32 v32, v14, v16
    v_xor_b32 v64, v14, v48
    v_xor_b32 v33, v14, v17
    v_xor_b32 v65, v14, v49
    v_xor_b32 v34, v14, v18
    v_xor_b32 v66, v14, v50
    v_xor_b32 v35, v14, v19
    v_xor_b32 v67, v14, v51
    v_xor_b32 v36, v14, v20
    v_xor_b32 v68, v14, v52
    v_xor_b32 v37, v14, v21
    v_xor_b32 v69, v14, v53
    v_xor_b32 v38, v14, v22
    v_xor_b32 v70, v14, v54
    v_xor_b32 v39, v14, v23
    v_xor_b32 v71, v14, v55
    v_xor_b32 v40, v14, v24
    v_xor_b32 v72, v14, v56
    v_xor_b32 v41, v14, v25
    v_xor_b32 v73, v14, v57
    v_xor_b32 v42, v14, v26
    v_xor_b32 v74, v14, v58
    v_xor_b32 v43, v14, v27
    v_xor_b32 v75, v14, v59
    v_xor_b32 v44, v14, v28
    v_xor_b32 v76, v14, v60
    v_xor_b32 v45, v14, v29
    v_xor_b32 v77, v14, v61
    v_xor_b32 v46, v14, v30
    v_xor_b32 v78, v14, v62
    v_xor_b32 v47, v14, v31
    v_xor_b32 v79, v14, v63
    s_branch L_oddend
    L_odd:
    v_xor_b32 v32, v14, v48
    v_xor_b32 v64, v15, v16
    v_xor_b32 v33, v14, v49
    v_xor_b32 v65, v15, v17
    v_xor_b32 v34, v14, v50
    v_xor_b32 v66, v15, v18
    v_xor_b32 v35, v14, v51
    v_xor_b32 v67, v15, v19
    v_xor_b32 v36, v14, v52
    v_xor_b32 v68, v15, v20
    v_xor_b32 v37, v14, v53
    v_xor_b32 v69, v15, v21
    v_xor_b32 v38, v14, v54
    v_xor_b32 v70, v15, v22
    v_xor_b32 v39, v14, v55
    v_xor_b32 v71, v15, v23
    v_xor_b32 v40, v14, v56
    v_xor_b32 v72, v15, v24
    v_xor_b32 v41, v14, v57
    v_xor_b32 v73, v15, v25
    v_xor_b32 v42, v14, v58
    v_xor_b32 v74, v15, v26
    v_xor_b32 v43, v14, v59
    v_xor_b32 v75, v15, v27
    v_xor_b32 v44, v14, v60
    v_xor_b32 v76, v15, v28
    v_xor_b32 v45, v14, v61
    v_xor_b32 v77, v15, v29
    v_xor_b32 v46, v14, v62
    v_xor_b32 v78, v15, v30
    v_xor_b32 v47, v14, v63
    v_xor_b32 v79, v15, v31
    L_oddend:
    s_cmp_lg_u32 s22, 0
    s_cbranch_scc1 L_nordy
    s_waitcnt vmcnt(8)
    v_mov_b32 v5, 1
    v_mov_b32 v6, 0
    s_mov_b64 exec, 1
    buffer_store_dword v5, v6, s[28:31], 0 offen sc1
    s_mov_b64 exec, -1
    L_nordy:
    v_add_u32 v5, 0, v4
    v_xor_b32 v5, v5, v3
    v_lshlrev_b32 v5, 4, v5
    v_lshl_add_u32 v5, v3, 10, v5
    v_add_u32 v104, 131072, v5
    v_add_u32 v5, 4, v4
    v_xor_b32 v5, v5, v3
    v_lshlrev_b32 v5, 4, v5
    v_lshl_add_u32 v5, v3, 10, v5
    v_add_u32 v105, 131072, v5
    v_add_u32 v5, 8, v4
    v_xor_b32 v5, v5, v3
    v_lshlrev_b32 v5, 4, v5
    v_lshl_add_u32 v5, v3, 10, v5
    v_add_u32 v106, 131072, v5
    v_add_u32 v5, 12, v4
    v_xor_b32 v5, v5, v3
    v_lshlrev_b32 v5, 4, v5
    v_lshl_add_u32 v5, v3, 10, v5
    v_add_u32 v107, 131072, v5
    v_lshrrev_b32 v5, 3, v2
    s_lshl_b32 s3, s16, 3
    v_add_u32 v5, s3, v5
    v_lshlrev_b32 v110, 2, v5
    v_add_u32 v110, 130944, v110
    v_and_b32 v6, 15, v5
    v_and_b32 v7, 7, v2
    v_xor_b32 v6, v6, v7
    v_lshlrev_b32 v6, 4, v6
    v_lshl_add_u32 v6, v5, 10, v6
    v_add_u32 v108, 131072, v6
    v_xor_b32 v109, 0x80, v108
    v_lshlrev_b32 v111, 4, v4
    v_add_u32 v111, 130944, v111
    v_mov_b32 v113, 0x3f803f80
    v_lshrrev_b32 v5, 1, v3
    v_add_u32 v5, 0, v5
    v_sub_u32 v6, 32, v5
    v_cmp_eq_u32 vcc, 0, v5
    s_nop 1
    v_cndmask_b32 v6, v6, 16, vcc
    v_and_b32 v7, 1, v3
    v_cmp_eq_u32 vcc, 1, v7
    s_nop 1
    v_cndmask_b32 v5, v5, v6, vcc
    v_cvt_f32_u32 v5, v5
    v_mul_f32 v5, 0x3a000000, v5
    v_lshlrev_b32 v6, 8, v4
    v_add_u32 v6, s18, v6
    v_cvt_f32_u32 v6, v6
    v_mul_f32 v6, v5, v6
    v_mov_b32 v8, v6
    v_fmamk_f32 v9, v5, 0x42800000, v6
    v_cos_f32 v10, v8
    v_cos_f32 v11, v9
    v_sin_f32 v12, v8
    v_sin_f32 v13, v9
    v_cvt_pk_bf16_f32 v80, v10, v11
    v_cvt_pk_bf16_f32 v88, v12, v13
    v_xor_b32 v96, 0x80008000, v88
    v_fmamk_f32 v8, v5, 0x43000000, v6
    v_fmamk_f32 v9, v5, 0x43400000, v6
    v_cos_f32 v10, v8
    v_cos_f32 v11, v9
    v_sin_f32 v12, v8
    v_sin_f32 v13, v9
    v_cvt_pk_bf16_f32 v81, v10, v11
    v_cvt_pk_bf16_f32 v89, v12, v13
    v_xor_b32 v97, 0x80008000, v89
    v_fmamk_f32 v8, v5, 0x44800000, v6
    v_fmamk_f32 v9, v5, 0x44880000, v6
    v_cos_f32 v10, v8
    v_cos_f32 v11, v9
    v_sin_f32 v12, v8
    v_sin_f32 v13, v9
    v_cvt_pk_bf16_f32 v82, v10, v11
    v_cvt_pk_bf16_f32 v90, v12, v13
    v_xor_b32 v98, 0x80008000, v90
    v_fmamk_f32 v8, v5, 0x44900000, v6
    v_fmamk_f32 v9, v5, 0x44980000, v6
    v_cos_f32 v10, v8
    v_cos_f32 v11, v9
    v_sin_f32 v12, v8
    v_sin_f32 v13, v9
    v_cvt_pk_bf16_f32 v83, v10, v11
    v_cvt_pk_bf16_f32 v91, v12, v13
    v_xor_b32 v99, 0x80008000, v91
    v_lshrrev_b32 v5, 1, v3
    v_add_u32 v5, 8, v5
    v_sub_u32 v6, 32, v5
    v_cmp_eq_u32 vcc, 0, v5
    s_nop 1
    v_cndmask_b32 v6, v6, 16, vcc
    v_and_b32 v7, 1, v3
    v_cmp_eq_u32 vcc, 1, v7
    s_nop 1
    v_cndmask_b32 v5, v5, v6, vcc
    v_cvt_f32_u32 v5, v5
    v_mul_f32 v5, 0x3a000000, v5
    v_lshlrev_b32 v6, 8, v4
    v_add_u32 v6, s18, v6
    v_cvt_f32_u32 v6, v6
    v_mul_f32 v6, v5, v6
    v_mov_b32 v8, v6
    v_fmamk_f32 v9, v5, 0x42800000, v6
    v_cos_f32 v10, v8
    v_cos_f32 v11, v9
    v_sin_f32 v12, v8
    v_sin_f32 v13, v9
    v_cvt_pk_bf16_f32 v84, v10, v11
    v_cvt_pk_bf16_f32 v92, v12, v13
    v_xor_b32 v100, 0x80008000, v92
    v_fmamk_f32 v8, v5, 0x43000000, v6
    v_fmamk_f32 v9, v5, 0x43400000, v6
    v_cos_f32 v10, v8
    v_cos_f32 v11, v9
    v_sin_f32 v12, v8
    v_sin_f32 v13, v9
    v_cvt_pk_bf16_f32 v85, v10, v11
    v_cvt_pk_bf16_f32 v93, v12, v13
    v_xor_b32 v101, 0x80008000, v93
    v_fmamk_f32 v8, v5, 0x44800000, v6
    v_fmamk_f32 v9, v5, 0x44880000, v6
    v_cos_f32 v10, v8
    v_cos_f32 v11, v9
    v_sin_f32 v12, v8
    v_sin_f32 v13, v9
    v_cvt_pk_bf16_f32 v86, v10, v11
    v_cvt_pk_bf16_f32 v94, v12, v13
    v_xor_b32 v102, 0x80008000, v94
    v_fmamk_f32 v8, v5, 0x44900000, v6
    v_fmamk_f32 v9, v5, 0x44980000, v6
    v_cos_f32 v10, v8
    v_cos_f32 v11, v9
    v_sin_f32 v12, v8
    v_sin_f32 v13, v9
    v_cvt_pk_bf16_f32 v87, v10, v11
    v_cvt_pk_bf16_f32 v95, v12, v13
    v_xor_b32 v103, 0x80008000, v95
    v_lshrrev_b32 v5, 1, v3
    v_lshlrev_b32 v5, 17, v5
    v_and_b32 v6, 1, v3
    v_lshl_add_u32 v5, v6, 6, v5
    v_lshl_add_u32 v112, v4, 4, v5
    s_lshl_b32 s3, s18, 11
    s_lshl_b32 s4, s19, 7
    s_add_u32 s21, s3, s4
    s_add_u32 s24, s21, 1048576
    s_lshl_b32 s3, s2, 5
    s_add_u32 s23, s3, 16777216
    s_mul_i32 s3, s2, 7168
    v_lshlrev_b32 v7, 4, v0
    v_add_u32 v8, 4096, v7
    buffer_load_dwordx4 a[0:3], v7, s[32:35], s3 offen
    buffer_load_dwordx4 a[4:7], v8, s[32:35], s3 offen
    buffer_load_dwordx4 a[8:11], v7, s[36:39], s3 offen
    buffer_load_dwordx4 a[12:15], v8, s[36:39], s3 offen
    buffer_load_dwordx4 a[16:19], v7, s[40:43], s3 offen
    buffer_load_dwordx4 a[20:23], v8, s[40:43], s3 offen
    s_and_b32 s3, s2, 3
    s_lshl_b32 s3, s3, 2
    s_bfe_u32 s4, s2, 0x20003
    s_add_u32 s50, s3, s4
    s_bfe_u32 s3, s2, 0x10002
    s_lshl_b32 s3, s3, 3
    s_lshr_b32 s4, s2, 5
    s_add_u32 s51, s3, s4
    s_and_b32 s5, s16, 1
    s_lshr_b32 s6, s16, 1
    s_cmp_ge_u32 s16, 2
    s_cselect_b32 s32, s36, s32
    s_cselect_b32 s33, s37, s33
    s_cselect_b32 s3, 12416, 0
    s_cselect_b32 s4, 65664, 0
    s_mul_i32 s7, s5, 6144
    s_add_u32 s3, s3, s7
    s_add_u32 s63, s3, 131072
    s_add_u32 s37, s4, s7
    s_lshl_b32 s3, s6, 16
    s_lshl_b32 s4, s5, 10
    s_add_u32 s49, s3, s4
    s_lshl_b32 s3, s51, 7
    s_mul_i32 s4, s5, 28672
    s_add_u32 s48, s3, s4
    s_mul_i32 s3, s51, 96
    s_mul_i32 s4, s5, 229376
    s_add_u32 s3, s3, s4
    s_add_u32 s62, s3, 2048
    v_lshrrev_b32 v5, 3, v2
    v_mul_u32_u24 v5, 0xe00, v5
    v_bfe_u32 v6, v2, 4, 1
    s_lshl_b32 s6, s6, 1
    v_or_b32 v6, s6, v6
    v_bfe_u32 v7, v2, 1, 2
    v_xor_b32 v6, v6, v7
    v_lshl_add_u32 v5, v6, 5, v5
    v_and_b32 v6, 1, v2
    v_lshl_add_u32 v244, v6, 4, v5
    v_add_u32 v248, 55296, v244
    v_mov_b32 v5, v2
    s_mov_b32 s4, 715827883
    v_mul_hi_u32 v6, v5, s4
    v_mul_u32_u24 v7, 6, v6
    v_sub_u32 v7, v5, v7
    v_mul_u32_u24 v6, 0xe00, v6
    v_lshl_add_u32 v245, v7, 4, v6
    v_add_u32 v5, 64, v5
    v_mul_hi_u32 v6, v5, s4
    v_mul_u32_u24 v7, 6, v6
    v_sub_u32 v7, v5, v7
    v_mul_u32_u24 v6, 0xe00, v6
    v_lshl_add_u32 v246, v7, 4, v6
    v_subrev_u32 v246, 1024, v246
    v_add_u32 v5, 64, v5
    v_mul_hi_u32 v6, v5, s4
    v_mul_u32_u24 v7, 6, v6
    v_sub_u32 v7, v5, v7
    v_mul_u32_u24 v6, 0xe00, v6
    v_lshl_add_u32 v247, v7, 4, v6
    v_subrev_u32 v247, 2048, v247
    s_lshl_b32 s3, s50, 1
    s_bfe_u32 s4, s2, 0x10002
    s_add_u32 s52, s3, s4
    s_lshr_b32 s53, s2, 5
    s_lshl_b32 s5, s16, 18
    s_lshl_b32 s3, s53, 7
    s_add_u32 s54, s3, s5
    s_mul_i32 s5, s16, 196608
    s_add_u32 s3, s3, s5
    s_add_u32 s39, s3, 1048576
    s_lshl_b32 s55, s16, 11
    v_lshrrev_b32 v5, 3, v2
    v_bfe_u32 v6, v2, 4, 1
    v_lshlrev_b32 v6, 2, v6
    v_and_b32 v7, 7, v2
    v_xor_b32 v6, v6, v7
    v_lshlrev_b32 v6, 4, v6
    v_lshl_add_u32 v251, v5, 10, v6
    v_add_u32 v252, 0x1c00, v251
    s_waitcnt vmcnt(6)
    s_barrier
    ds_read_b128 v[148:151], v104 offset:0
    ds_read_b128 v[152:155], v104 offset:16384
    ds_read_b128 v[156:159], v105 offset:0
    ds_read_b128 v[160:163], v105 offset:16384
    ds_read_b128 v[116:119], v108 offset:0
    ds_read_b128 v[120:123], v109 offset:0
    ds_read_b128 v[124:127], v108 offset:256
    ds_read_b128 v[128:131], v109 offset:256
    ds_read_b128 v[132:135], v108 offset:512
    ds_read_b128 v[136:139], v109 offset:512
    ds_read_b128 v[140:143], v108 offset:768
    ds_read_b128 v[144:147], v109 offset:768
    ds_read_b128 v[164:167], v106 offset:0
    ds_read_b128 v[168:171], v106 offset:16384
    ds_read_b128 v[172:175], v107 offset:0
    s_waitcnt lgkmcnt(14)
    v_mfma_f32_16x16x32_bf16 v[196:199], v[148:151], v[16:19], 0
    v_mfma_f32_16x16x32_bf16 v[200:203], v[148:151], v[48:51], 0
    ds_read_b128 v[176:179], v107 offset:16384
    s_waitcnt lgkmcnt(14)
    v_mfma_f32_16x16x32_bf16 v[204:207], v[152:155], v[16:19], 0
    v_mfma_f32_16x16x32_bf16 v[208:211], v[152:155], v[48:51], 0
    ds_read_b128 v[180:183], v104 offset:256
    s_waitcnt lgkmcnt(14)
    v_mfma_f32_16x16x32_bf16 v[196:199], v[156:159], v[20:23], v[196:199]
    v_mfma_f32_16x16x32_bf16 v[200:203], v[156:159], v[52:55], v[200:203]
    ds_read_b128 v[184:187], v104 offset:16640
    s_waitcnt lgkmcnt(14)
    v_mfma_f32_16x16x32_bf16 v[204:207], v[160:163], v[20:23], v[204:207]
    v_mfma_f32_16x16x32_bf16 v[208:211], v[160:163], v[52:55], v[208:211]
    ds_read_b128 v[188:191], v105 offset:256
    ds_read_b128 v[192:195], v105 offset:16640
    ds_read_b128 v[148:151], v106 offset:256
    s_waitcnt lgkmcnt(8)
    v_mfma_f32_16x16x32_bf16 v[196:199], v[164:167], v[24:27], v[196:199]
    v_dot2_f32_bf16 v5, v116, v113, 0
    v_dot2_f32_bf16 v7, v116, v116, 0
    v_mfma_f32_16x16x32_bf16 v[200:203], v[164:167], v[56:59], v[200:203]
    v_dot2_f32_bf16 v6, v117, v113, 0
    v_dot2_f32_bf16 v8, v117, v117, 0
    ds_read_b128 v[152:155], v106 offset:16640
    s_waitcnt lgkmcnt(8)
    v_mfma_f32_16x16x32_bf16 v[204:207], v[168:171], v[24:27], v[204:207]
    v_dot2_f32_bf16 v5, v118, v113, v5
    v_dot2_f32_bf16 v7, v118, v118, v7
    v_mfma_f32_16x16x32_bf16 v[208:211], v[168:171], v[56:59], v[208:211]
    v_dot2_f32_bf16 v6, v119, v113, v6
    v_dot2_f32_bf16 v8, v119, v119, v8
    ds_read_b128 v[156:159], v107 offset:256
    s_waitcnt lgkmcnt(8)
    v_mfma_f32_16x16x32_bf16 v[196:199], v[172:175], v[28:31], v[196:199]
    v_dot2_f32_bf16 v5, v120, v113, v5
    v_dot2_f32_bf16 v7, v120, v120, v7
    v_mfma_f32_16x16x32_bf16 v[200:203], v[172:175], v[60:63], v[200:203]
    v_dot2_f32_bf16 v6, v121, v113, v6
    v_dot2_f32_bf16 v8, v121, v121, v8
    ds_read_b128 v[160:163], v107 offset:16640
    s_waitcnt lgkmcnt(8)
    v_mfma_f32_16x16x32_bf16 v[204:207], v[176:179], v[28:31], v[204:207]
    v_dot2_f32_bf16 v5, v122, v113, v5
    v_dot2_f32_bf16 v7, v122, v122, v7
    v_mfma_f32_16x16x32_bf16 v[208:211], v[176:179], v[60:63], v[208:211]
    v_dot2_f32_bf16 v6, v123, v113, v6
    v_dot2_f32_bf16 v8, v123, v123, v8
    ds_read_b128 v[164:167], v104 offset:512
    s_waitcnt lgkmcnt(8)
    v_mfma_f32_16x16x32_bf16 v[196:199], v[180:183], v[32:35], v[196:199]
    v_dot2_f32_bf16 v5, v124, v113, v5
    v_dot2_f32_bf16 v7, v124, v124, v7
    v_mfma_f32_16x16x32_bf16 v[200:203], v[180:183], v[64:67], v[200:203]
    v_dot2_f32_bf16 v6, v125, v113, v6
    v_dot2_f32_bf16 v8, v125, v125, v8
    ds_read_b128 v[168:171], v104 offset:16896
    s_waitcnt lgkmcnt(8)
    v_mfma_f32_16x16x32_bf16 v[204:207], v[184:187], v[32:35], v[204:207]
    v_dot2_f32_bf16 v5, v126, v113, v5
    v_dot2_f32_bf16 v7, v126, v126, v7
    v_mfma_f32_16x16x32_bf16 v[208:211], v[184:187], v[64:67], v[208:211]
    v_dot2_f32_bf16 v6, v127, v113, v6
    v_dot2_f32_bf16 v8, v127, v127, v8
    ds_read_b128 v[172:175], v105 offset:512
    s_waitcnt lgkmcnt(8)
    v_mfma_f32_16x16x32_bf16 v[196:199], v[188:191], v[36:39], v[196:199]
    v_dot2_f32_bf16 v5, v128, v113, v5
    v_dot2_f32_bf16 v7, v128, v128, v7
    v_mfma_f32_16x16x32_bf16 v[200:203], v[188:191], v[68:71], v[200:203]
    v_dot2_f32_bf16 v6, v129, v113, v6
    v_dot2_f32_bf16 v8, v129, v129, v8
    ds_read_b128 v[176:179], v105 offset:16896
    s_waitcnt lgkmcnt(8)
    v_mfma_f32_16x16x32_bf16 v[204:207], v[192:195], v[36:39], v[204:207]
    v_dot2_f32_bf16 v5, v130, v113, v5
    v_dot2_f32_bf16 v7, v130, v130, v7
    v_mfma_f32_16x16x32_bf16 v[208:211], v[192:195], v[68:71], v[208:211]
    v_dot2_f32_bf16 v6, v131, v113, v6
    v_dot2_f32_bf16 v8, v131, v131, v8
    ds_read_b128 v[180:183], v106 offset:512
    s_waitcnt lgkmcnt(8)
    v_mfma_f32_16x16x32_bf16 v[196:199], v[148:151], v[40:43], v[196:199]
    v_dot2_f32_bf16 v5, v132, v113, v5
    v_dot2_f32_bf16 v7, v132, v132, v7
    v_mfma_f32_16x16x32_bf16 v[200:203], v[148:151], v[72:75], v[200:203]
    v_dot2_f32_bf16 v6, v133, v113, v6
    v_dot2_f32_bf16 v8, v133, v133, v8
    ds_read_b128 v[184:187], v106 offset:16896
    s_waitcnt lgkmcnt(8)
    v_mfma_f32_16x16x32_bf16 v[204:207], v[152:155], v[40:43], v[204:207]
    v_dot2_f32_bf16 v5, v134, v113, v5
    v_dot2_f32_bf16 v7, v134, v134, v7
    v_mfma_f32_16x16x32_bf16 v[208:211], v[152:155], v[72:75], v[208:211]
    v_dot2_f32_bf16 v6, v135, v113, v6
    v_dot2_f32_bf16 v8, v135, v135, v8
    ds_read_b128 v[188:191], v107 offset:512
    s_waitcnt lgkmcnt(8)
    v_mfma_f32_16x16x32_bf16 v[196:199], v[156:159], v[44:47], v[196:199]
    v_dot2_f32_bf16 v5, v136, v113, v5
    v_dot2_f32_bf16 v7, v136, v136, v7
    v_mfma_f32_16x16x32_bf16 v[200:203], v[156:159], v[76:79], v[200:203]
    v_dot2_f32_bf16 v6, v137, v113, v6
    v_dot2_f32_bf16 v8, v137, v137, v8
    ds_read_b128 v[192:195], v107 offset:16896
    s_waitcnt lgkmcnt(8)
    v_mfma_f32_16x16x32_bf16 v[204:207], v[160:163], v[44:47], v[204:207]
    v_dot2_f32_bf16 v5, v138, v113, v5
    v_dot2_f32_bf16 v7, v138, v138, v7
    v_mfma_f32_16x16x32_bf16 v[208:211], v[160:163], v[76:79], v[208:211]
    v_dot2_f32_bf16 v6, v139, v113, v6
    v_dot2_f32_bf16 v8, v139, v139, v8
    ds_read_b128 v[148:151], v104 offset:768
    s_waitcnt lgkmcnt(8)
    v_mfma_f32_16x16x32_bf16 v[212:215], v[164:167], v[16:19], 0
    v_dot2_f32_bf16 v5, v140, v113, v5
    v_dot2_f32_bf16 v7, v140, v140, v7
    v_mfma_f32_16x16x32_bf16 v[216:219], v[164:167], v[48:51], 0
    v_dot2_f32_bf16 v6, v141, v113, v6
    v_dot2_f32_bf16 v8, v141, v141, v8
    ds_read_b128 v[152:155], v104 offset:17152
    s_waitcnt lgkmcnt(8)
    v_mfma_f32_16x16x32_bf16 v[220:223], v[168:171], v[16:19], 0
    v_dot2_f32_bf16 v5, v142, v113, v5
    v_dot2_f32_bf16 v7, v142, v142, v7
    v_mfma_f32_16x16x32_bf16 v[224:227], v[168:171], v[48:51], 0
    v_dot2_f32_bf16 v6, v143, v113, v6
    v_dot2_f32_bf16 v8, v143, v143, v8
    ds_read_b128 v[156:159], v105 offset:768
    s_waitcnt lgkmcnt(8)
    v_mfma_f32_16x16x32_bf16 v[212:215], v[172:175], v[20:23], v[212:215]
    v_dot2_f32_bf16 v5, v144, v113, v5
    v_dot2_f32_bf16 v7, v144, v144, v7
    v_mfma_f32_16x16x32_bf16 v[216:219], v[172:175], v[52:55], v[216:219]
    v_dot2_f32_bf16 v6, v145, v113, v6
    v_dot2_f32_bf16 v8, v145, v145, v8
    ds_read_b128 v[160:163], v105 offset:17152
    s_waitcnt lgkmcnt(8)
    v_mfma_f32_16x16x32_bf16 v[220:223], v[176:179], v[20:23], v[220:223]
    v_dot2_f32_bf16 v5, v146, v113, v5
    v_dot2_f32_bf16 v7, v146, v146, v7
    v_mfma_f32_16x16x32_bf16 v[224:227], v[176:179], v[52:55], v[224:227]
    v_dot2_f32_bf16 v6, v147, v113, v6
    v_dot2_f32_bf16 v8, v147, v147, v8
    ds_read_b128 v[164:167], v106 offset:768
    s_waitcnt lgkmcnt(8)
    v_mfma_f32_16x16x32_bf16 v[212:215], v[180:183], v[24:27], v[212:215]
    v_mfma_f32_16x16x32_bf16 v[216:219], v[180:183], v[56:59], v[216:219]
    v_add_f32 v5, v5, v6
    v_add_f32 v7, v7, v8
    ds_read_b128 v[168:171], v106 offset:17152
    s_waitcnt lgkmcnt(8)
    v_mfma_f32_16x16x32_bf16 v[220:223], v[184:187], v[24:27], v[220:223]
    v_add_f32 v5, v5, v5 quad_perm:[1,0,3,2] row_mask:0xf bank_mask:0xf
    v_add_f32 v7, v7, v7 quad_perm:[1,0,3,2] row_mask:0xf bank_mask:0xf
    v_mfma_f32_16x16x32_bf16 v[224:227], v[184:187], v[56:59], v[224:227]
    v_add_f32 v5, v5, v5 quad_perm:[2,3,0,1] row_mask:0xf bank_mask:0xf
    v_add_f32 v7, v7, v7 quad_perm:[2,3,0,1] row_mask:0xf bank_mask:0xf
    ds_read_b128 v[172:175], v107 offset:768
    s_waitcnt lgkmcnt(8)
    v_mfma_f32_16x16x32_bf16 v[212:215], v[188:191], v[28:31], v[212:215]
    v_add_f32 v5, v5, v5 row_half_mirror row_mask:0xf bank_mask:0xf
    v_add_f32 v7, v7, v7 row_half_mirror row_mask:0xf bank_mask:0xf
    v_mfma_f32_16x16x32_bf16 v[216:219], v[188:191], v[60:63], v[216:219]
    v_mul_f32 v5, 0x3b000000, v5
    v_mov_b32 v6, 0x3727c5ac
    ds_read_b128 v[176:179], v107 offset:17152
    s_waitcnt lgkmcnt(8)
    v_mfma_f32_16x16x32_bf16 v[220:223], v[192:195], v[28:31], v[220:223]
    v_fmac_f32 v6, 0x3b000000, v7
    v_fma_f32 v7, -v5, v5, v6
    v_mfma_f32_16x16x32_bf16 v[224:227], v[192:195], v[60:63], v[224:227]
    v_max_f32 v7, 0x3727c5ac, v7
    v_rsq_f32 v7, v7
    s_waitcnt lgkmcnt(7)
    v_mfma_f32_16x16x32_bf16 v[212:215], v[148:151], v[32:35], v[212:215]
    ds_write_b32 v110, v7
    v_mfma_f32_16x16x32_bf16 v[216:219], v[148:151], v[64:67], v[216:219]
    s_waitcnt lgkmcnt(7)
    v_mfma_f32_16x16x32_bf16 v[220:223], v[152:155], v[32:35], v[220:223]
    v_mfma_f32_16x16x32_bf16 v[224:227], v[152:155], v[64:67], v[224:227]
    s_waitcnt lgkmcnt(6)
    v_mfma_f32_16x16x32_bf16 v[212:215], v[156:159], v[36:39], v[212:215]
    v_mfma_f32_16x16x32_bf16 v[216:219], v[156:159], v[68:71], v[216:219]
    s_waitcnt lgkmcnt(5)
    v_mfma_f32_16x16x32_bf16 v[220:223], v[160:163], v[36:39], v[220:223]
    v_mfma_f32_16x16x32_bf16 v[224:227], v[160:163], v[68:71], v[224:227]
    s_waitcnt lgkmcnt(4)
    v_mfma_f32_16x16x32_bf16 v[212:215], v[164:167], v[40:43], v[212:215]
    v_mfma_f32_16x16x32_bf16 v[216:219], v[164:167], v[72:75], v[216:219]
    s_waitcnt lgkmcnt(3)
    v_mfma_f32_16x16x32_bf16 v[220:223], v[168:171], v[40:43], v[220:223]
    v_mfma_f32_16x16x32_bf16 v[224:227], v[168:171], v[72:75], v[224:227]
    s_waitcnt lgkmcnt(2)
    v_mfma_f32_16x16x32_bf16 v[212:215], v[172:175], v[44:47], v[212:215]
    v_mfma_f32_16x16x32_bf16 v[216:219], v[172:175], v[76:79], v[216:219]
    s_waitcnt lgkmcnt(1)
    v_mfma_f32_16x16x32_bf16 v[220:223], v[176:179], v[44:47], v[220:223]
    v_mfma_f32_16x16x32_bf16 v[224:227], v[176:179], v[76:79], v[224:227]
    s_waitcnt lgkmcnt(0)
    s_barrier
    ds_read_b128 v[116:119], v111
    ds_read_b128 v[120:123], v111 offset:64
    v_mov_b32 v9, 0
    buffer_load_dword v12, v9, s[28:31], 0 offen sc1
    v_fma_f32 v196, s20, v212, v196
    v_fma_f32 v197, s20, v213, v197
    v_fma_f32 v198, s20, v214, v198
    v_fma_f32 v199, s20, v215, v199
    v_fma_f32 v200, s20, v216, v200
    v_fma_f32 v201, s20, v217, v201
    v_fma_f32 v202, s20, v218, v202
    v_fma_f32 v203, s20, v219, v203
    v_fma_f32 v204, s20, v220, v204
    v_fma_f32 v205, s20, v221, v205
    v_fma_f32 v206, s20, v222, v206
    v_fma_f32 v207, s20, v223, v207
    v_fma_f32 v208, s20, v224, v208
    v_fma_f32 v209, s20, v225, v209
    v_fma_f32 v210, s20, v226, v210
    v_fma_f32 v211, s20, v227, v211
    s_waitcnt lgkmcnt(0)
    v_mul_f32 v196, v116, v196
    v_mul_f32 v197, v117, v197
    v_mul_f32 v198, v118, v198
    v_mul_f32 v199, v119, v199
    v_cvt_pk_bf16_f32 v148, v196, v197
    v_cvt_pk_bf16_f32 v149, v198, v199
    v_mul_f32 v204, v120, v204
    v_mul_f32 v205, v121, v205
    v_mul_f32 v206, v122, v206
    v_mul_f32 v207, v123, v207
    v_cvt_pk_bf16_f32 v150, v204, v205
    v_cvt_pk_bf16_f32 v151, v206, v207
    v_mul_f32 v200, v116, v200
    v_mul_f32 v201, v117, v201
    v_mul_f32 v202, v118, v202
    v_mul_f32 v203, v119, v203
    v_cvt_pk_bf16_f32 v152, v200, v201
    v_cvt_pk_bf16_f32 v153, v202, v203
    v_mul_f32 v208, v120, v208
    v_mul_f32 v209, v121, v209
    v_mul_f32 v210, v122, v210
    v_mul_f32 v211, v123, v211
    v_cvt_pk_bf16_f32 v154, v208, v209
    v_cvt_pk_bf16_f32 v155, v210, v211
    v_mfma_f32_16x16x32_bf16 v[212:215], v[148:151], v[80:83], 0
    s_nop 0
    v_mfma_f32_16x16x32_bf16 v[216:219], v[152:155], v[80:83], 0
    v_mfma_f32_16x16x32_bf16 v[212:215], v[152:155], v[88:91], v[212:215]
    v_mfma_f32_16x16x32_bf16 v[216:219], v[148:151], v[96:99], v[216:219]
    v_mfma_f32_16x16x32_bf16 v[220:223], v[148:151], v[84:87], 0
    v_mfma_f32_16x16x32_bf16 v[224:227], v[152:155], v[84:87], 0
    v_mfma_f32_16x16x32_bf16 v[220:223], v[152:155], v[92:95], v[220:223]
    v_mfma_f32_16x16x32_bf16 v[224:227], v[148:151], v[100:103], v[224:227]
    s_nop 2
    v_cvt_pk_bf16_f32 v196, v212, v213
    v_cvt_pk_bf16_f32 v197, v214, v215
    v_cvt_pk_bf16_f32 v198, v216, v217
    v_cvt_pk_bf16_f32 v199, v218, v219
    buffer_store_dwordx4 v[196:199], v112, s[12:15], s21 offen sc1
    v_cvt_pk_bf16_f32 v200, v220, v221
    v_cvt_pk_bf16_f32 v201, v222, v223
    v_cvt_pk_bf16_f32 v202, v224, v225
    v_cvt_pk_bf16_f32 v203, v226, v227
    buffer_store_dwordx4 v[200:203], v112, s[12:15], s24 offen sc1
    s_waitcnt vmcnt(0)
    s_barrier
    s_cmp_lg_u32 s16, 0
    s_cbranch_scc1 L_nf1
    v_readfirstlane_b32 s3, v12
    s_nop 0
    s_cmp_eq_u32 s3, 1
    s_cbranch_scc1 L_rdyok
    v_mov_b32 v12, 0
    s_mov_b32 s3, 0
    L_poll2:
    s_add_u32 s3, s3, 1
    s_cmp_gt_u32 s3, 0x80000
    s_cbranch_scc1 L_pe3
    buffer_load_dword v8, v12, s[28:31], 0 offen sc1
    s_waitcnt vmcnt(0)
    v_cmp_eq_u32 vcc, 1, v8
    s_nop 0
    s_cmp_eq_u64 vcc, exec
    s_cbranch_scc0 L_poll2
    L_pe3:
    L_rdyok:
    v_mov_b32 v8, 1
    v_mov_b32 v9, 0
    s_mov_b64 exec, 1
    buffer_store_dword v8, v9, s[12:15], s23 offen sc1
    s_mov_b64 exec, -1
    L_nf1:
    s_and_b32 s17, s2, 15
    s_add_u32 m0, s49, 0
    s_nop 0
    buffer_load_dwordx4 v244, s[32:35], s48 offen lds
    buffer_load_dwordx4 v248, s[32:35], s48 offen offset:2048 lds
    s_add_u32 s48, s48, 114688
    s_lshr_b32 s18, s2, 4
    s_sub_u32 s19, 32, s17
    s_cmp_eq_u32 s17, 0
    s_cselect_b32 s19, 16, s19
    s_cmp_ge_u32 s16, 2
    s_cselect_b32 s6, s19, s17
    s_lshl_b32 s7, s18, 2
    s_and_b32 s20, s16, 1
    s_lshl_b32 s20, s20, 1
    s_add_u32 s7, s7, s20
    s_lshl_b32 s7, s7, 5
    s_add_u32 s6, s6, s7
    s_lshl_b32 s21, s6, 10
    v_lshrrev_b32 v6, 5, v2
    v_lshlrev_b32 v6, 15, v6
    v_and_b32 v13, 31, v2
    v_lshl_add_u32 v12, v13, 4, v6
    buffer_load_dwordx4 v[16:19], v12, s[8:11], s21 offen
    s_add_u32 m0, s49, 4096
    s_nop 0
    buffer_load_dwordx4 v244, s[32:35], s48 offen lds
    buffer_load_dwordx4 v248, s[32:35], s48 offen offset:2048 lds
    s_add_u32 s48, s48, 114688
    buffer_load_dwordx4 v[20:23], v12, s[8:11], s21 offen offset:512
    v_and_b32 v5, 3, v3
    s_lshl_b32 s3, s18, 2
    v_add_u32 v5, s3, v5
    v_lshrrev_b32 v6, 2, v3
    v_add_u32 v7, 62, v6
    v_sub_u32 v7, v7, v5
    v_cmp_eq_u32 vcc, 0, v6
    s_nop 1
    v_cndmask_b32 v5, v7, v5, vcc
    v_cvt_f32_u32 v5, v5
    v_mul_f32 v5, 0x3c800000, v5
    s_and_b32 s27, s18, 0
    s_lshl_b32 s3, s27, 4
    v_lshl_add_u32 v6, v4, 2, s3
    v_cvt_f32_u32 v6, v6
    v_mul_f32 v6, v5, v6
    v_mov_b32 v7, v6
    v_cos_f32 v8, v7
    s_add_u32 m0, s49, 8192
    s_nop 0
    buffer_load_dwordx4 v244, s[32:35], s48 offen lds
    buffer_load_dwordx4 v248, s[32:35], s48 offen offset:2048 lds
    s_add_u32 s48, s48, 114688
    v_sin_f32 v9, v7
    s_nop 0
    v_cvt_pk_bf16_f32 v24, v8, v9
    v_fmamk_f32 v7, v5, 0x3f800000, v6
    v_cos_f32 v8, v7
    v_sin_f32 v9, v7
    s_nop 0
    v_cvt_pk_bf16_f32 v25, v8, v9
    v_fmamk_f32 v7, v5, 0x40000000, v6
    v_cos_f32 v8, v7
    v_sin_f32 v9, v7
    s_nop 0
    v_cvt_pk_bf16_f32 v26, v8, v9
    v_fmamk_f32 v7, v5, 0x40400000, v6
    v_cos_f32 v8, v7
    v_sin_f32 v9, v7
    s_nop 0
    v_cvt_pk_bf16_f32 v27, v8, v9
    s_add_u32 m0, s49, 12288
    s_nop 0
    buffer_load_dwordx4 v244, s[32:35], s48 offen lds
    buffer_load_dwordx4 v248, s[32:35], s48 offen offset:2048 lds
    s_add_u32 s48, s48, 114688
    v_fmamk_f32 v7, v5, 0x41800000, v6
    v_cos_f32 v8, v7
    v_sin_f32 v9, v7
    s_nop 0
    v_cvt_pk_bf16_f32 v28, v8, v9
    v_fmamk_f32 v7, v5, 0x41880000, v6
    v_cos_f32 v8, v7
    v_sin_f32 v9, v7
    s_nop 0
    v_cvt_pk_bf16_f32 v29, v8, v9
    v_fmamk_f32 v7, v5, 0x41900000, v6
    v_cos_f32 v8, v7
    v_sin_f32 v9, v7
    s_nop 0
    v_cvt_pk_bf16_f32 v30, v8, v9
    v_fmamk_f32 v7, v5, 0x41980000, v6
    v_cos_f32 v8, v7
    v_sin_f32 v9, v7
    s_add_u32 m0, s49, 16384
    s_nop 0
    buffer_load_dwordx4 v244, s[32:35], s48 offen lds
    buffer_load_dwordx4 v248, s[32:35], s48 offen offset:2048 lds
    s_add_u32 s48, s48, 114688
    s_nop 0
    v_cvt_pk_bf16_f32 v31, v8, v9
    v_fmamk_f32 v7, v5, 0x42000000, v6
    v_cos_f32 v8, v7
    v_sin_f32 v9, v7
    s_nop 0
    v_cvt_pk_bf16_f32 v32, v8, v9
    v_fmamk_f32 v7, v5, 0x42040000, v6
    v_cos_f32 v8, v7
    v_sin_f32 v9, v7
    s_nop 0
    v_cvt_pk_bf16_f32 v33, v8, v9
    v_fmamk_f32 v7, v5, 0x42080000, v6
    v_cos_f32 v8, v7
    v_sin_f32 v9, v7
    s_nop 0
    v_cvt_pk_bf16_f32 v34, v8, v9
    v_fmamk_f32 v7, v5, 0x420c0000, v6
    s_add_u32 m0, s49, 20480
    s_nop 0
    buffer_load_dwordx4 v244, s[32:35], s48 offen lds
    buffer_load_dwordx4 v248, s[32:35], s48 offen offset:2048 lds
    s_add_u32 s48, s48, 114688
    v_cos_f32 v8, v7
    v_sin_f32 v9, v7
    s_nop 0
    v_cvt_pk_bf16_f32 v35, v8, v9
    v_fmamk_f32 v7, v5, 0x42400000, v6
    v_cos_f32 v8, v7
    v_sin_f32 v9, v7
    s_nop 0
    v_cvt_pk_bf16_f32 v36, v8, v9
    v_fmamk_f32 v7, v5, 0x42440000, v6
    v_cos_f32 v8, v7
    v_sin_f32 v9, v7
    s_nop 0
    v_cvt_pk_bf16_f32 v37, v8, v9
    v_fmamk_f32 v7, v5, 0x42480000, v6
    v_cos_f32 v8, v7
    v_sin_f32 v9, v7
    s_nop 0
    s_add_u32 m0, s49, 24576
    s_nop 0
    buffer_load_dwordx4 v244, s[32:35], s48 offen lds
    buffer_load_dwordx4 v248, s[32:35], s48 offen offset:2048 lds
    s_add_u32 s48, s48, 114688
    v_cvt_pk_bf16_f32 v38, v8, v9
    v_fmamk_f32 v7, v5, 0x424c0000, v6
    v_cos_f32 v8, v7
    v_sin_f32 v9, v7
    s_nop 0
    v_cvt_pk_bf16_f32 v39, v8, v9
    v_lshlrev_b32 v14, 13, v4
    v_lshl_add_u32 v14, v3, 4, v14
    v_add_u32 v15, 0x1000, v14
    s_lshl_b32 s3, s17, 17
    s_lshl_b32 s4, s16, 9
    s_add_u32 s1, s3, s4
    s_lshl_b32 s27, s27, 15
    s_add_u32 s24, s1, s27
    s_add_u32 s27, s1, 131072
    s_lshl_b32 s3, s16, 7
    s_cmp_lt_u32 s16, 2
    s_cselect_b32 s4, 1, -254
    s_add_u32 m0, s49, 28672
    s_nop 0
    buffer_load_dwordx4 v244, s[32:35], s48 offen lds
    buffer_load_dwordx4 v248, s[32:35], s48 offen offset:2048 lds
    s_add_u32 s48, s48, 114688
    s_add_u32 s3, s3, s4
    v_lshrrev_b32 v5, 3, v3
    v_lshlrev_b32 v5, 5, v5
    v_and_b32 v6, 3, v3
    v_lshl_add_u32 v5, v6, 3, v5
    v_add_u32 v5, s3, v5
    v_sub_u32 v6, 0x200, v5
    v_cmp_eq_u32 vcc, 0, v4
    s_nop 1
    v_cndmask_b32 v5, v6, v5, vcc
    v_lshlrev_b32 v5, 2, v5
    v_cndmask_b32 v6, -8, 8, vcc
    s_cmp_eq_u32 s17, 0
    s_cselect_b32 s3, 0, 1
    v_mov_b32 v7, s3
    v_cndmask_b32 v7, v7, 0, vcc
    v_bfe_u32 v8, v3, 2, 1
    v_xor_b32 v7, v7, v8
    v_lshl_add_u32 v5, v7, 13, v5
    s_add_u32 m0, s49, 32768
    s_nop 0
    buffer_load_dwordx4 v244, s[32:35], s48 offen lds
    buffer_load_dwordx4 v248, s[32:35], s48 offen offset:2048 lds
    s_add_u32 s48, s48, 114688
    v_add_u32 v40, 147456, v5
    v_add_u32 v41, v6, v40
    v_add_u32 v42, v6, v41
    v_add_u32 v43, v6, v42
    v_lshlrev_b32 v6, 5, v6
    v_add_u32 v44, v6, v40
    v_add_u32 v45, v6, v41
    v_add_u32 v46, v6, v42
    v_add_u32 v47, v6, v43
    v_or_b32 v8, s3, v8
    v_sub_u32 v8, 2, v8
    v_cmp_eq_u32 s[58:59], v8, v4
    s_nop 0
    s_or_b64 s[58:59], s[58:59], vcc
    v_and_b32 v5, 7, v2
    v_lshlrev_b32 v5, 11, v5
    v_add_u32 v5, 147456, v5
    v_mov_b32 v6, 0
    ds_write_b32 v5, v6
    s_add_u32 m0, s49, 36864
    s_nop 0
    buffer_load_dwordx4 v244, s[32:35], s48 offen lds
    buffer_load_dwordx4 v248, s[32:35], s48 offen offset:2048 lds
    s_add_u32 s48, s48, 114688
    s_lshl_b32 s3, s16, 12
    s_add_u32 s3, s3, 147456
    v_lshrrev_b32 v5, 5, v2
    v_lshlrev_b32 v6, 11, v5
    v_lshl_add_u32 v6, v13, 5, v6
    v_add_u32 v48, s3, v6
    s_lshl_b32 s4, s16, 2
    v_lshl_add_u32 v6, v5, 1, s4
    v_add_u32 v6, v6, v13
    v_and_b32 v6, 63, v6
    v_lshlrev_b32 v6, 4, v6
    v_lshl_add_u32 v6, v5, 10, v6
    v_add_u32 v50, s3, v6
    v_xor_b32 v6, 0x200, v6
    v_add_u32 v51, s3, v6
    v_lshrrev_b32 v5, 3, v2
    v_and_b32 v6, 7, v2
    v_lshrrev_b32 v7, 1, v5
    s_add_u32 m0, s49, 40960
    s_nop 0
    buffer_load_dwordx4 v244, s[32:35], s48 offen lds
    buffer_load_dwordx4 v248, s[32:35], s48 offen offset:2048 lds
    s_add_u32 s48, s48, 114688
    v_lshlrev_b32 v7, 10, v7
    v_and_b32 v8, 1, v5
    v_lshl_add_u32 v7, v8, 9, v7
    v_lshl_add_u32 v49, v6, 4, v7
    s_lshl_b32 s4, s16, 4
    v_lshl_add_u32 v5, v6, 1, v5
    v_add_u32 v5, s4, v5
    v_lshrrev_b32 v7, 1, v6
    v_lshlrev_b32 v7, 12, v7
    v_and_b32 v8, 1, v6
    v_lshl_add_u32 v7, v8, 10, v7
    v_add_u32 v7, 147456, v7
    v_and_b32 v8, 63, v5
    v_lshl_add_u32 v254, v8, 4, v7
    v_add_u32 v5, 8, v5
    v_and_b32 v8, 63, v5
    v_lshl_add_u32 v255, v8, 4, v7
    s_lshl_b32 s3, s17, 2
    s_add_u32 m0, s49, 45056
    s_nop 0
    buffer_load_dwordx4 v244, s[32:35], s48 offen lds
    buffer_load_dwordx4 v248, s[32:35], s48 offen offset:2048 lds
    s_add_u32 s48, s48, 114688
    s_lshr_b32 s4, s18, 2
    s_add_u32 s3, s3, s4
    s_lshl_b32 s3, s3, 15
    s_and_b32 s4, s18, 3
    s_lshl_b32 s4, s4, 7
    s_add_u32 s3, s3, s4
    s_lshl_b32 s4, s16, 13
    s_add_u32 s3, s3, s4
    s_add_u32 s22, s3, 2097152
    s_add_u32 s23, s22, 4096
    s_add_u32 s25, s21, 4194304
    s_lshl_b32 s5, s17, 9
    s_lshl_b32 s4, s18, 5
    s_add_u32 s5, s5, s4
    s_add_u32 s26, s5, 16785408
    s_mov_b32 s56, 0x05040100
    s_mov_b32 s57, 0x07060302
    s_mov_b32 s20, 16777216
    v_lshlrev_b32 v7, 5, v0
    s_mov_b32 s3, 0
    L_poll4:
    s_add_u32 s3, s3, 1
    s_cmp_gt_u32 s3, 0x80000
    s_cbranch_scc1 L_pe5
    buffer_load_dword v8, v7, s[12:15], s20 offen sc1
    s_waitcnt vmcnt(0)
    v_cmp_eq_u32 vcc, 1, v8
    s_nop 0
    s_cmp_eq_u64 vcc, exec
    s_cbranch_scc0 L_poll4
    L_pe5:
    s_barrier
    buffer_load_dwordx4 v[116:119], v14, s[12:15], s24 offen offset:0 sc1
    buffer_load_dwordx4 v[120:123], v14, s[12:15], s24 offen offset:2048 sc1
    buffer_load_dwordx4 v[124:127], v15, s[12:15], s24 offen offset:0 sc1
    buffer_load_dwordx4 v[128:131], v15, s[12:15], s24 offen offset:2048 sc1
    buffer_load_dwordx4 v[132:135], v14, s[12:15], s24 offen offset:256 sc1
    buffer_load_dwordx4 v[136:139], v14, s[12:15], s24 offen offset:2304 sc1
    buffer_load_dwordx4 v[140:143], v15, s[12:15], s24 offen offset:256 sc1
    buffer_load_dwordx4 v[144:147], v15, s[12:15], s24 offen offset:2304 sc1
    s_add_u32 s24, s24, 32768
    s_cmp_eq_u32 s24, s27
    s_cselect_b32 s24, s1, s24
    buffer_load_dwordx4 v[148:151], v14, s[12:15], s24 offen offset:0 sc1
    buffer_load_dwordx4 v[152:155], v14, s[12:15], s24 offen offset:2048 sc1
    buffer_load_dwordx4 v[156:159], v15, s[12:15], s24 offen offset:0 sc1
    buffer_load_dwordx4 v[160:163], v15, s[12:15], s24 offen offset:2048 sc1
    buffer_load_dwordx4 v[164:167], v14, s[12:15], s24 offen offset:256 sc1
    buffer_load_dwordx4 v[168:171], v14, s[12:15], s24 offen offset:2304 sc1
    buffer_load_dwordx4 v[172:175], v15, s[12:15], s24 offen offset:256 sc1
    buffer_load_dwordx4 v[176:179], v15, s[12:15], s24 offen offset:2304 sc1
    s_add_u32 s24, s24, 32768
    s_cmp_eq_u32 s24, s27
    s_cselect_b32 s24, s1, s24
    buffer_load_dwordx4 v[180:183], v14, s[12:15], s24 offen offset:0 sc1
    buffer_load_dwordx4 v[184:187], v14, s[12:15], s24 offen offset:2048 sc1
    buffer_load_dwordx4 v[188:191], v15, s[12:15], s24 offen offset:0 sc1
    buffer_load_dwordx4 v[192:195], v15, s[12:15], s24 offen offset:2048 sc1
    buffer_load_dwordx4 v[196:199], v14, s[12:15], s24 offen offset:256 sc1
    buffer_load_dwordx4 v[200:203], v14, s[12:15], s24 offen offset:2304 sc1
    buffer_load_dwordx4 v[204:207], v15, s[12:15], s24 offen offset:256 sc1
    buffer_load_dwordx4 v[208:211], v15, s[12:15], s24 offen offset:2304 sc1
    s_add_u32 s24, s24, 32768
    s_cmp_eq_u32 s24, s27
    s_cselect_b32 s24, s1, s24
    buffer_load_dwordx4 v[212:215], v14, s[12:15], s24 offen offset:0 sc1
    buffer_load_dwordx4 v[216:219], v14, s[12:15], s24 offen offset:2048 sc1
    buffer_load_dwordx4 v[220:223], v15, s[12:15], s24 offen offset:0 sc1
    buffer_load_dwordx4 v[224:227], v15, s[12:15], s24 offen offset:2048 sc1
    buffer_load_dwordx4 v[228:231], v14, s[12:15], s24 offen offset:256 sc1
    buffer_load_dwordx4 v[232:235], v14, s[12:15], s24 offen offset:2304 sc1
    buffer_load_dwordx4 v[236:239], v15, s[12:15], s24 offen offset:256 sc1
    buffer_load_dwordx4 v[240:243], v15, s[12:15], s24 offen offset:2304 sc1
    s_waitcnt vmcnt(28)
    v_perm_b32 v84, v118, v116, s56
    v_perm_b32 v85, v122, v120, s56
    v_perm_b32 v86, v126, v124, s56
    v_perm_b32 v87, v130, v128, s56
    v_perm_b32 v88, v118, v116, s57
    v_perm_b32 v89, v122, v120, s57
    v_perm_b32 v90, v126, v124, s57
    v_perm_b32 v91, v130, v128, s57
    v_perm_b32 v92, v119, v117, s56
    v_perm_b32 v93, v123, v121, s56
    v_perm_b32 v94, v127, v125, s56
    v_perm_b32 v95, v131, v129, s56
    v_perm_b32 v96, v119, v117, s57
    v_perm_b32 v97, v123, v121, s57
    v_perm_b32 v98, v127, v125, s57
    v_perm_b32 v99, v131, v129, s57
    v_mfma_f32_16x16x32_bf16 v[52:55], v[24:27], v[84:87], 0
    v_mfma_f32_16x16x32_bf16 v[56:59], v[24:27], v[88:91], 0
    v_mfma_f32_16x16x32_bf16 v[60:63], v[24:27], v[92:95], 0
    v_mfma_f32_16x16x32_bf16 v[64:67], v[24:27], v[96:99], 0
    s_waitcnt vmcnt(24)
    v_perm_b32 v100, v134, v132, s56
    v_perm_b32 v101, v138, v136, s56
    v_perm_b32 v102, v142, v140, s56
    v_perm_b32 v103, v146, v144, s56
    v_perm_b32 v104, v134, v132, s57
    v_perm_b32 v105, v138, v136, s57
    v_perm_b32 v106, v142, v140, s57
    v_perm_b32 v107, v146, v144, s57
    v_perm_b32 v108, v135, v133, s56
    v_perm_b32 v109, v139, v137, s56
    v_perm_b32 v110, v143, v141, s56
    v_perm_b32 v111, v147, v145, s56
    v_perm_b32 v112, v135, v133, s57
    v_perm_b32 v113, v139, v137, s57
    v_perm_b32 v114, v143, v141, s57
    v_perm_b32 v115, v147, v145, s57
    v_mfma_f32_16x16x32_bf16 v[68:71], v[24:27], v[100:103], 0
    v_mfma_f32_16x16x32_bf16 v[72:75], v[24:27], v[104:107], 0
    v_mfma_f32_16x16x32_bf16 v[76:79], v[24:27], v[108:111], 0
    v_mfma_f32_16x16x32_bf16 v[80:83], v[24:27], v[112:115], 0
    s_waitcnt vmcnt(20)
    v_perm_b32 v84, v150, v148, s56
    v_perm_b32 v85, v154, v152, s56
    v_perm_b32 v86, v158, v156, s56
    v_perm_b32 v87, v162, v160, s56
    v_perm_b32 v88, v150, v148, s57
    v_perm_b32 v89, v154, v152, s57
    v_perm_b32 v90, v158, v156, s57
    v_perm_b32 v91, v162, v160, s57
    v_perm_b32 v92, v151, v149, s56
    v_perm_b32 v93, v155, v153, s56
    v_perm_b32 v94, v159, v157, s56
    v_perm_b32 v95, v163, v161, s56
    v_perm_b32 v96, v151, v149, s57
    v_perm_b32 v97, v155, v153, s57
    v_perm_b32 v98, v159, v157, s57
    v_perm_b32 v99, v163, v161, s57
    v_mfma_f32_16x16x32_bf16 v[52:55], v[28:31], v[84:87], v[52:55]
    v_mfma_f32_16x16x32_bf16 v[56:59], v[28:31], v[88:91], v[56:59]
    v_mfma_f32_16x16x32_bf16 v[60:63], v[28:31], v[92:95], v[60:63]
    v_mfma_f32_16x16x32_bf16 v[64:67], v[28:31], v[96:99], v[64:67]
    s_waitcnt vmcnt(16)
    v_perm_b32 v100, v166, v164, s56
    v_perm_b32 v101, v170, v168, s56
    v_perm_b32 v102, v174, v172, s56
    v_perm_b32 v103, v178, v176, s56
    v_perm_b32 v104, v166, v164, s57
    v_perm_b32 v105, v170, v168, s57
    v_perm_b32 v106, v174, v172, s57
    v_perm_b32 v107, v178, v176, s57
    v_perm_b32 v108, v167, v165, s56
    v_perm_b32 v109, v171, v169, s56
    v_perm_b32 v110, v175, v173, s56
    v_perm_b32 v111, v179, v177, s56
    v_perm_b32 v112, v167, v165, s57
    v_perm_b32 v113, v171, v169, s57
    v_perm_b32 v114, v175, v173, s57
    v_perm_b32 v115, v179, v177, s57
    v_mfma_f32_16x16x32_bf16 v[68:71], v[28:31], v[100:103], v[68:71]
    v_mfma_f32_16x16x32_bf16 v[72:75], v[28:31], v[104:107], v[72:75]
    v_mfma_f32_16x16x32_bf16 v[76:79], v[28:31], v[108:111], v[76:79]
    v_mfma_f32_16x16x32_bf16 v[80:83], v[28:31], v[112:115], v[80:83]
    s_waitcnt vmcnt(12)
    v_perm_b32 v84, v182, v180, s56
    v_perm_b32 v85, v186, v184, s56
    v_perm_b32 v86, v190, v188, s56
    v_perm_b32 v87, v194, v192, s56
    v_perm_b32 v88, v182, v180, s57
    v_perm_b32 v89, v186, v184, s57
    v_perm_b32 v90, v190, v188, s57
    v_perm_b32 v91, v194, v192, s57
    v_perm_b32 v92, v183, v181, s56
    v_perm_b32 v93, v187, v185, s56
    v_perm_b32 v94, v191, v189, s56
    v_perm_b32 v95, v195, v193, s56
    v_perm_b32 v96, v183, v181, s57
    v_perm_b32 v97, v187, v185, s57
    v_perm_b32 v98, v191, v189, s57
    v_perm_b32 v99, v195, v193, s57
    v_mfma_f32_16x16x32_bf16 v[52:55], v[32:35], v[84:87], v[52:55]
    v_mfma_f32_16x16x32_bf16 v[56:59], v[32:35], v[88:91], v[56:59]
    v_mfma_f32_16x16x32_bf16 v[60:63], v[32:35], v[92:95], v[60:63]
    v_mfma_f32_16x16x32_bf16 v[64:67], v[32:35], v[96:99], v[64:67]
    s_waitcnt vmcnt(8)
    v_perm_b32 v100, v198, v196, s56
    v_perm_b32 v101, v202, v200, s56
    v_perm_b32 v102, v206, v204, s56
    v_perm_b32 v103, v210, v208, s56
    v_perm_b32 v104, v198, v196, s57
    v_perm_b32 v105, v202, v200, s57
    v_perm_b32 v106, v206, v204, s57
    v_perm_b32 v107, v210, v208, s57
    v_perm_b32 v108, v199, v197, s56
    v_perm_b32 v109, v203, v201, s56
    v_perm_b32 v110, v207, v205, s56
    v_perm_b32 v111, v211, v209, s56
    v_perm_b32 v112, v199, v197, s57
    v_perm_b32 v113, v203, v201, s57
    v_perm_b32 v114, v207, v205, s57
    v_perm_b32 v115, v211, v209, s57
    v_mfma_f32_16x16x32_bf16 v[68:71], v[32:35], v[100:103], v[68:71]
    v_mfma_f32_16x16x32_bf16 v[72:75], v[32:35], v[104:107], v[72:75]
    v_mfma_f32_16x16x32_bf16 v[76:79], v[32:35], v[108:111], v[76:79]
    v_mfma_f32_16x16x32_bf16 v[80:83], v[32:35], v[112:115], v[80:83]
    s_waitcnt vmcnt(4)
    v_perm_b32 v84, v214, v212, s56
    v_perm_b32 v85, v218, v216, s56
    v_perm_b32 v86, v222, v220, s56
    v_perm_b32 v87, v226, v224, s56
    v_perm_b32 v88, v214, v212, s57
    v_perm_b32 v89, v218, v216, s57
    v_perm_b32 v90, v222, v220, s57
    v_perm_b32 v91, v226, v224, s57
    v_perm_b32 v92, v215, v213, s56
    v_perm_b32 v93, v219, v217, s56
    v_perm_b32 v94, v223, v221, s56
    v_perm_b32 v95, v227, v225, s56
    v_perm_b32 v96, v215, v213, s57
    v_perm_b32 v97, v219, v217, s57
    v_perm_b32 v98, v223, v221, s57
    v_perm_b32 v99, v227, v225, s57
    v_mfma_f32_16x16x32_bf16 v[52:55], v[36:39], v[84:87], v[52:55]
    v_mfma_f32_16x16x32_bf16 v[56:59], v[36:39], v[88:91], v[56:59]
    v_mfma_f32_16x16x32_bf16 v[60:63], v[36:39], v[92:95], v[60:63]
    v_mfma_f32_16x16x32_bf16 v[64:67], v[36:39], v[96:99], v[64:67]
    s_waitcnt vmcnt(0)
    v_perm_b32 v100, v230, v228, s56
    v_perm_b32 v101, v234, v232, s56
    v_perm_b32 v102, v238, v236, s56
    v_perm_b32 v103, v242, v240, s56
    v_perm_b32 v104, v230, v228, s57
    v_perm_b32 v105, v234, v232, s57
    v_perm_b32 v106, v238, v236, s57
    v_perm_b32 v107, v242, v240, s57
    v_perm_b32 v108, v231, v229, s56
    v_perm_b32 v109, v235, v233, s56
    v_perm_b32 v110, v239, v237, s56
    v_perm_b32 v111, v243, v241, s56
    v_perm_b32 v112, v231, v229, s57
    v_perm_b32 v113, v235, v233, s57
    v_perm_b32 v114, v239, v237, s57
    v_perm_b32 v115, v243, v241, s57
    v_mfma_f32_16x16x32_bf16 v[68:71], v[36:39], v[100:103], v[68:71]
    v_mfma_f32_16x16x32_bf16 v[72:75], v[36:39], v[104:107], v[72:75]
    v_mfma_f32_16x16x32_bf16 v[76:79], v[36:39], v[108:111], v[76:79]
    v_mfma_f32_16x16x32_bf16 v[80:83], v[36:39], v[112:115], v[80:83]
    v_lshlrev_b32 v100, 16, v16
    s_add_u32 m0, s49, 49152
    s_nop 0
    buffer_load_dwordx4 v244, s[32:35], s48 offen lds
    buffer_load_dwordx4 v248, s[32:35], s48 offen offset:2048 lds
    s_add_u32 s48, s48, 114688
    v_and_b32 v101, 0xffff0000, v16
    v_lshlrev_b32 v102, 16, v17
    v_and_b32 v103, 0xffff0000, v17
    v_lshlrev_b32 v104, 16, v18
    v_and_b32 v105, 0xffff0000, v18
    v_lshlrev_b32 v106, 16, v19
    v_and_b32 v107, 0xffff0000, v19
    v_lshlrev_b32 v108, 16, v20
    v_and_b32 v109, 0xffff0000, v20
    v_lshlrev_b32 v110, 16, v21
    v_and_b32 v111, 0xffff0000, v21
    v_lshlrev_b32 v112, 16, v22
    v_and_b32 v113, 0xffff0000, v22
    v_lshlrev_b32 v114, 16, v23
    v_and_b32 v115, 0xffff0000, v23
    s_mov_b64 exec, s[58:59]
    ds_write_b32 v40, v52 offset:0
    ds_write_b32 v40, v53 offset:2048
    ds_write_b32 v40, v54 offset:4096
    ds_write_b32 v40, v55 offset:6144
    ds_write_b32 v41, v56 offset:0
    ds_write_b32 v41, v57 offset:2048
    ds_write_b32 v41, v58 offset:4096
    ds_write_b32 v41, v59 offset:6144
    ds_write_b32 v42, v60 offset:0
    ds_write_b32 v42, v61 offset:2048
    ds_write_b32 v42, v62 offset:4096
    ds_write_b32 v42, v63 offset:6144
    ds_write_b32 v43, v64 offset:0
    ds_write_b32 v43, v65 offset:2048
    ds_write_b32 v43, v66 offset:4096
    ds_write_b32 v43, v67 offset:6144
    ds_write_b32 v44, v68 offset:0
    ds_write_b32 v44, v69 offset:2048
    ds_write_b32 v44, v70 offset:4096
    ds_write_b32 v44, v71 offset:6144
    ds_write_b32 v45, v72 offset:0
    ds_write_b32 v45, v73 offset:2048
    ds_write_b32 v45, v74 offset:4096
    ds_write_b32 v45, v75 offset:6144
    ds_write_b32 v46, v76 offset:0
    ds_write_b32 v46, v77 offset:2048
    ds_write_b32 v46, v78 offset:4096
    ds_write_b32 v46, v79 offset:6144
    ds_write_b32 v47, v80 offset:0
    ds_write_b32 v47, v81 offset:2048
    ds_write_b32 v47, v82 offset:4096
    ds_write_b32 v47, v83 offset:6144
    s_mov_b64 exec, -1
    s_add_u32 m0, s49, 53248
    s_nop 0
    buffer_load_dwordx4 v244, s[32:35], s48 offen lds
    buffer_load_dwordx4 v248, s[32:35], s48 offen offset:2048 lds
    s_add_u32 s48, s48, 114688
    s_waitcnt lgkmcnt(0)
    s_add_u32 m0, s49, 57344
    s_nop 0
    buffer_load_dwordx4 v244, s[32:35], s48 offen lds
    buffer_load_dwordx4 v248, s[32:35], s48 offen offset:2048 lds
    s_add_u32 s48, s48, 114688
    s_barrier
    ds_read_b128 v[52:55], v48 offset:0
    ds_read_b128 v[56:59], v48 offset:16
    ds_read_b128 v[60:63], v48 offset:1024
    ds_read_b128 v[64:67], v48 offset:1040
    s_waitcnt lgkmcnt(3)
    v_add_f32 v52, v52, v100
    v_add_f32 v53, v53, v101
    v_add_f32 v54, v54, v102
    v_add_f32 v55, v55, v103
    s_add_u32 m0, s49, 61440
    s_nop 0
    buffer_load_dwordx4 v244, s[32:35], s48 offen lds
    buffer_load_dwordx4 v248, s[32:35], s48 offen offset:2048 lds
    s_add_u32 s48, s48, 114688
    s_waitcnt lgkmcnt(2)
    v_add_f32 v56, v56, v104
    v_add_f32 v57, v57, v105
    v_add_f32 v58, v58, v106
    v_add_f32 v59, v59, v107
    s_waitcnt lgkmcnt(1)
    v_add_f32 v60, v60, v108
    v_add_f32 v61, v61, v109
    v_add_f32 v62, v62, v110
    v_add_f32 v63, v63, v111
    s_waitcnt lgkmcnt(0)
    v_add_f32 v64, v64, v112
    v_add_f32 v65, v65, v113
    v_add_f32 v66, v66, v114
    v_add_f32 v67, v67, v115
    v_cvt_pk_bf16_f32 v16, v52, v53
    v_cvt_pk_bf16_f32 v17, v54, v55
    v_cvt_pk_bf16_f32 v18, v56, v57
    v_cvt_pk_bf16_f32 v19, v58, v59
    v_cvt_pk_bf16_f32 v20, v60, v61
    buffer_load_dwordx4 a[128:131], v251, s[40:43], s39 offen offset:0
    buffer_load_dwordx4 a[132:135], v252, s[40:43], s39 offen offset:1024
    s_add_u32 s39, s39, 16384
    v_cvt_pk_bf16_f32 v21, v62, v63
    v_cvt_pk_bf16_f32 v22, v64, v65
    v_cvt_pk_bf16_f32 v23, v66, v67
    v_mov_b32 v8, 0x3f803f80
    v_dot2_f32_bf16 v5, v16, v8, 0
    v_dot2_f32_bf16 v10, v16, v16, 0
    v_dot2_f32_bf16 v6, v17, v8, 0
    v_dot2_f32_bf16 v11, v17, v17, 0
    v_dot2_f32_bf16 v5, v18, v8, v5
    v_dot2_f32_bf16 v10, v18, v18, v10
    v_dot2_f32_bf16 v6, v19, v8, v6
    v_dot2_f32_bf16 v11, v19, v19, v11
    v_dot2_f32_bf16 v5, v20, v8, v5
    v_dot2_f32_bf16 v10, v20, v20, v10
    v_dot2_f32_bf16 v6, v21, v8, v6
    v_dot2_f32_bf16 v11, v21, v21, v11
    v_dot2_f32_bf16 v5, v22, v8, v5
    v_dot2_f32_bf16 v10, v22, v22, v10
    v_dot2_f32_bf16 v6, v23, v8, v6
    v_dot2_f32_bf16 v11, v23, v23, v11
    buffer_load_dwordx4 a[136:139], v251, s[40:43], s39 offen offset:0
    buffer_load_dwordx4 a[140:143], v252, s[40:43], s39 offen offset:1024
    s_add_u32 s39, s39, 16384
    buffer_store_dwordx4 v[16:19], v12, s[12:15], s25 offen sc1
    buffer_store_dwordx4 v[20:23], v12, s[12:15], s25 offen offset:512 sc1
    v_lshlrev_b32 v100, 16, v16
    v_add_f32 v5, v5, v6
    v_add_f32 v10, v10, v11
    v_and_b32 v101, 0xffff0000, v16
    v_lshlrev_b32 v102, 16, v17
    v_add_f32 v5, v5, v5 quad_perm:[1,0,3,2] row_mask:0xf bank_mask:0xf
    v_add_f32 v10, v10, v10 quad_perm:[1,0,3,2] row_mask:0xf bank_mask:0xf
    v_and_b32 v103, 0xffff0000, v17
    v_lshlrev_b32 v104, 16, v18
    v_add_f32 v5, v5, v5 quad_perm:[2,3,0,1] row_mask:0xf bank_mask:0xf
    v_add_f32 v10, v10, v10 quad_perm:[2,3,0,1] row_mask:0xf bank_mask:0xf
    v_and_b32 v105, 0xffff0000, v18
    v_lshlrev_b32 v106, 16, v19
    v_add_f32 v5, v5, v5 row_half_mirror row_mask:0xf bank_mask:0xf
    v_add_f32 v10, v10, v10 row_half_mirror row_mask:0xf bank_mask:0xf
    v_and_b32 v107, 0xffff0000, v19
    v_lshlrev_b32 v108, 16, v20
    v_add_f32 v5, v5, v5 row_mirror row_mask:0xf bank_mask:0xf
    buffer_load_dwordx4 a[144:147], v251, s[40:43], s39 offen offset:0
    buffer_load_dwordx4 a[148:151], v252, s[40:43], s39 offen offset:1024
    s_add_u32 s39, s39, 16384
    v_add_f32 v10, v10, v10 row_mirror row_mask:0xf bank_mask:0xf
    v_mov_b32 v6, v5
    v_mov_b32 v11, v10
    v_and_b32 v109, 0xffff0000, v20
    v_lshlrev_b32 v110, 16, v21
    v_permlane16_swap_b32 v5, v6
    v_permlane16_swap_b32 v10, v11
    v_and_b32 v111, 0xffff0000, v21
    v_add_f32 v5, v5, v6
    v_add_f32 v10, v10, v11
    v_mul_f32 v5, 0xbb000000, v5
    v_mov_b32 v6, 0x3727c5ac
    v_fmac_f32 v6, 0x3b000000, v10
    v_fma_f32 v6, -v5, v5, v6
    v_max_f32 v6, 0x3727c5ac, v6
    v_rsq_f32 v6, v6
    v_lshlrev_b32 v112, 16, v22
    v_and_b32 v113, 0xffff0000, v22
    v_lshlrev_b32 v114, 16, v23
    v_and_b32 v115, 0xffff0000, v23
    buffer_load_dwordx4 a[152:155], v251, s[40:43], s39 offen offset:0
    buffer_load_dwordx4 a[156:159], v252, s[40:43], s39 offen offset:1024
    s_add_u32 s39, s39, 16384
    v_mul_f32 v8, v5, v6
    v_fma_f32 v100, v100, v6, v8
    v_fma_f32 v101, v101, v6, v8
    v_fma_f32 v102, v102, v6, v8
    v_fma_f32 v103, v103, v6, v8
    v_fma_f32 v104, v104, v6, v8
    v_fma_f32 v105, v105, v6, v8
    v_fma_f32 v106, v106, v6, v8
    v_fma_f32 v107, v107, v6, v8
    v_fma_f32 v108, v108, v6, v8
    v_fma_f32 v109, v109, v6, v8
    v_fma_f32 v110, v110, v6, v8
    v_fma_f32 v111, v111, v6, v8
    v_fma_f32 v112, v112, v6, v8
    v_fma_f32 v113, v113, v6, v8
    v_fma_f32 v114, v114, v6, v8
    v_fma_f32 v115, v115, v6, v8
    v_cvt_pk_bf16_f32 v52, v100, v101
    v_cvt_pk_bf16_f32 v53, v102, v103
    v_cvt_pk_bf16_f32 v54, v104, v105
    v_cvt_pk_bf16_f32 v55, v106, v107
    v_cvt_pk_bf16_f32 v56, v108, v109
    v_cvt_pk_bf16_f32 v57, v110, v111
    v_cvt_pk_bf16_f32 v58, v112, v113
    v_cvt_pk_bf16_f32 v59, v114, v115
    ds_write_b128 v50, v[52:55]
    ds_write_b128 v51, v[56:59]
    s_waitcnt lgkmcnt(0)
    s_barrier
    ds_read_b128 v[52:55], v254
    ds_read_b128 v[56:59], v255
    s_waitcnt lgkmcnt(1)
    buffer_store_dwordx4 v[52:55], v49, s[12:15], s22 offen sc1
    s_waitcnt lgkmcnt(0)
    buffer_store_dwordx4 v[56:59], v49, s[12:15], s23 offen sc1
    s_lshl_b32 s3, s50, 2
    s_add_u32 s3, s3, s16
    s_lshl_b32 s17, s3, 15
    s_add_u32 s17, s17, 2097152
    s_lshl_b32 s5, s50, 9
    s_add_u32 s20, s5, 16785408
    s_lshl_b32 s4, s51, 5
    s_add_u32 s5, s5, s4
    s_add_u32 s21, s5, 16793600
    s_add_u32 s22, s5, 16801792
    s_mul_i32 s3, s3, 114688
    s_add_u32 s3, s3, 6291456
    s_lshl_b32 s4, s51, 12
    s_add_u32 s23, s3, s4
    s_mul_i32 s4, s51, 3072
    s_add_u32 s3, s3, s4
    s_add_u32 s24, s3, 65536
    s_lshr_b32 s3, s52, 1
    s_lshl_b32 s3, s3, 9
    s_lshl_b32 s4, s16, 7
    s_add_u32 s3, s3, s4
    s_add_u32 s56, s3, 16793600
    s_add_u32 s57, s3, 16801792
    v_lshrrev_b32 v5, 5, v2
    v_bfe_u32 v6, v2, 2, 2
    v_lshl_add_u32 v5, v5, 3, v6
    v_bfe_u32 v6, v2, 4, 1
    v_and_b32 v7, 1, v2
    v_lshlrev_b32 v7, 3, v7
    v_lshl_add_u32 v7, v6, 4, v7
    v_bfe_u32 v8, v2, 1, 1
    v_lshl_add_u32 v9, v5, 7, v7
    v_lshl_add_u32 v9, v8, 16, v9
    v_bfe_u32 v6, v2, 3, 1
    v_lshl_or_b32 v6, v8, 1, v6
    v_xor_b32 v10, 0, v6
    v_lshl_add_u32 v12, v10, 5, v9
    v_xor_b32 v10, 1, v6
    v_lshl_add_u32 v13, v10, 5, v9
    v_xor_b32 v10, 2, v6
    v_lshl_add_u32 v14, v10, 5, v9
    v_xor_b32 v10, 3, v6
    v_lshl_add_u32 v15, v10, 5, v9
    v_mul_u32_u24 v5, 96, v5
    v_add_u32 v5, v5, v7
    v_mul_u32_u24 v6, 12416, v8
    v_add_u32 v6, v5, v6
    v_add_u32 v16, 0x20000, v6
    v_mul_u32_u24 v6, 65664, v8
    v_add_u32 v17, v5, v6
    s_mov_b32 s60, 0xbdd2d3e8
    s_mov_b32 s61, 0xbdd2d3e8
    v_mov_b32 v18, 0xc0135761
    v_mov_b32 v19, 0xc0135761
    v_mov_b32 v20, 1.0
    v_mov_b32 v21, 1.0
    v_lshlrev_b32 v7, 5, v3
    v_and_b32 v6, 3, v2
    v_lshlrev_b32 v22, 5, v6
    s_waitcnt vmcnt(0)
    s_barrier
    s_cmp_lg_u32 s16, 0
    s_cbranch_scc1 L_nf6
    v_mov_b32 v8, 1
    v_mov_b32 v9, 0
    s_mov_b64 exec, 1
    buffer_store_dword v8, v9, s[12:15], s26 offen sc1
    s_mov_b64 exec, -1
    L_nf6:
    s_lshr_b32 s5, s52, 1
    s_sub_u32 s6, 32, s5
    s_cmp_eq_u32 s5, 0
    s_cselect_b32 s6, 16, s6
    v_lshrrev_b32 v6, 3, v0
    s_and_b32 s3, s52, 1
    s_lshl_b32 s3, s3, 6
    v_add_u32 v6, s3, v6
    v_lshrrev_b32 v7, 3, v6
    v_lshlrev_b32 v7, 2, v7
    v_and_b32 v8, 3, v6
    v_add_u32 v7, v7, v8
    v_lshlrev_b32 v7, 5, v7
    v_mov_b32 v8, s5
    v_mov_b32 v9, s6
    v_and_b32 v6, 4, v6
    v_cmp_eq_u32 vcc, 0, v6
    s_nop 1
    v_cndmask_b32 v8, v9, v8, vcc
    v_add_u32 v7, v7, v8
    v_lshlrev_b32 v7, 10, v7
    v_and_b32 v6, 7, v0
    v_lshl_add_u32 v208, v6, 4, v7
    v_add_u32 v209, 524288, v208
    s_lshl_b32 s58, s53, 7
    s_add_u32 s59, s58, 4194304
    v_lshrrev_b32 v6, 5, v2
    v_lshlrev_b32 v6, 9, v6
    v_bfe_u32 v7, v2, 2, 2
    v_lshl_add_u32 v6, v7, 7, v6
    v_bfe_u32 v7, v2, 3, 1
    v_lshl_add_u32 v6, v7, 6, v6
    v_bfe_u32 v7, v2, 4, 1
    v_lshl_add_u32 v6, v7, 5, v6
    v_and_b32 v7, 3, v2
    v_lshl_add_u32 v6, v7, 3, v6
    v_add_u32 v210, s55, v6
    v_xor_b32 v211, 64, v210
    v_add_u32 v212, 0x10000, v210
    v_add_u32 v213, 0x10000, v211
    v_add_u32 v214, 0x10000, v212
    v_add_u32 v215, 0x10000, v213
    v_add_u32 v217, s55, v253
    v_add_u32 v218, 0x10000, v217
    v_add_u32 v219, 0x20000, v217
    v_lshlrev_b32 v7, 5, v3
    buffer_load_dwordx4 a[160:163], v251, s[40:43], s39 offen offset:0
    buffer_load_dwordx4 a[164:167], v252, s[40:43], s39 offen offset:1024
    s_add_u32 s39, s39, 16384
    buffer_load_dwordx4 a[168:171], v251, s[40:43], s39 offen offset:0
    buffer_load_dwordx4 a[172:175], v252, s[40:43], s39 offen offset:1024
    s_add_u32 s39, s39, 16384
    buffer_load_dwordx4 a[176:179], v251, s[40:43], s39 offen offset:0
    buffer_load_dwordx4 a[180:183], v252, s[40:43], s39 offen offset:1024
    s_add_u32 s39, s39, 16384
    buffer_load_dwordx4 a[184:187], v251, s[40:43], s39 offen offset:0
    buffer_load_dwordx4 a[188:191], v252, s[40:43], s39 offen offset:1024
    s_add_u32 s39, s39, 16384
    ds_read_b64_tr_b16 v[24:25], v12 offset:0
    ds_read_b64_tr_b16 v[26:27], v12 offset:512
    ds_read_b64_tr_b16 v[28:29], v13 offset:0
    ds_read_b64_tr_b16 v[30:31], v13 offset:512
    ds_read_b64_tr_b16 v[32:33], v14 offset:0
    ds_read_b64_tr_b16 v[34:35], v14 offset:512
    ds_read_b64_tr_b16 v[36:37], v15 offset:0
    ds_read_b64_tr_b16 v[38:39], v15 offset:512
    ds_read_b64_tr_b16 v[40:41], v12 offset:2048
    ds_read_b64_tr_b16 v[42:43], v12 offset:2560
    ds_read_b64_tr_b16 v[44:45], v13 offset:2048
    ds_read_b64_tr_b16 v[46:47], v13 offset:2560
    ds_read_b64_tr_b16 v[48:49], v14 offset:2048
    ds_read_b64_tr_b16 v[50:51], v14 offset:2560
    ds_read_b64_tr_b16 v[52:53], v15 offset:2048
    ds_read_b64_tr_b16 v[54:55], v15 offset:2560
    s_cmp_lg_u32 s16, 0
    s_cbranch_scc1 L_np7
    s_mov_b32 s3, 0
    L_poll8:
    s_add_u32 s3, s3, 1
    s_cmp_gt_u32 s3, 0x80000
    s_cbranch_scc1 L_pe9
    buffer_load_dword v8, v7, s[12:15], s20 offen sc1
    s_waitcnt vmcnt(0)
    v_cmp_eq_u32 vcc, 1, v8
    s_nop 0
    s_cmp_eq_u64 vcc, exec
    s_cbranch_scc0 L_poll8
    L_pe9:
    L_np7:
    s_barrier
    buffer_load_dwordx4 a[0:3], v253, s[12:15], s17 offen offset:0 sc1
    buffer_load_dwordx4 a[4:7], v253, s[12:15], s17 offen offset:1024 sc1
    buffer_load_dwordx4 a[8:11], v253, s[12:15], s17 offen offset:2048 sc1
    buffer_load_dwordx4 a[12:15], v253, s[12:15], s17 offen offset:3072 sc1
    s_add_u32 s17, s17, 4096
    buffer_load_dwordx4 a[16:19], v253, s[12:15], s17 offen offset:0 sc1
    buffer_load_dwordx4 a[20:23], v253, s[12:15], s17 offen offset:1024 sc1
    buffer_load_dwordx4 a[24:27], v253, s[12:15], s17 offen offset:2048 sc1
    buffer_load_dwordx4 a[28:31], v253, s[12:15], s17 offen offset:3072 sc1
    s_add_u32 s17, s17, 4096
    buffer_load_dwordx4 a[32:35], v253, s[12:15], s17 offen offset:0 sc1
    buffer_load_dwordx4 a[36:39], v253, s[12:15], s17 offen offset:1024 sc1
    buffer_load_dwordx4 a[40:43], v253, s[12:15], s17 offen offset:2048 sc1
    buffer_load_dwordx4 a[44:47], v253, s[12:15], s17 offen offset:3072 sc1
    s_add_u32 s17, s17, 4096
    buffer_load_dwordx4 a[48:51], v253, s[12:15], s17 offen offset:0 sc1
    buffer_load_dwordx4 a[52:55], v253, s[12:15], s17 offen offset:1024 sc1
    buffer_load_dwordx4 a[56:59], v253, s[12:15], s17 offen offset:2048 sc1
    buffer_load_dwordx4 a[60:63], v253, s[12:15], s17 offen offset:3072 sc1
    s_add_u32 s17, s17, 4096
    s_waitcnt vmcnt(15)
    s_waitcnt lgkmcnt(8)
    v_mfma_f32_32x32x16_bf16 v[80:95], v[24:27], a[0:3], 0
    ds_read_b64_tr_b16 v[56:57], v12 offset:4096
    ds_read_b64_tr_b16 v[58:59], v12 offset:4608
    v_mfma_f32_32x32x16_bf16 v[96:111], v[28:31], a[0:3], 0
    ds_read_b64_tr_b16 v[60:61], v13 offset:4096
    ds_read_b64_tr_b16 v[62:63], v13 offset:4608
    buffer_load_dwordx4 a[64:67], v253, s[12:15], s17 offen offset:0 sc1
    buffer_load_dwordx4 a[68:71], v253, s[12:15], s17 offen offset:1024 sc1
    v_mfma_f32_32x32x16_bf16 v[112:127], v[32:35], a[0:3], 0
    ds_read_b64_tr_b16 v[64:65], v14 offset:4096
    ds_read_b64_tr_b16 v[66:67], v14 offset:4608
    v_mfma_f32_32x32x16_bf16 v[128:143], v[36:39], a[0:3], 0
    ds_read_b64_tr_b16 v[68:69], v15 offset:4096
    ds_read_b64_tr_b16 v[70:71], v15 offset:4608
    s_waitcnt vmcnt(16)
    s_waitcnt lgkmcnt(8)
    v_mfma_f32_32x32x16_bf16 v[80:95], v[40:43], a[4:7], v[80:95]
    ds_read_b64_tr_b16 v[24:25], v12 offset:6144
    ds_read_b64_tr_b16 v[26:27], v12 offset:6656
    v_mfma_f32_32x32x16_bf16 v[96:111], v[44:47], a[4:7], v[96:111]
    ds_read_b64_tr_b16 v[28:29], v13 offset:6144
    ds_read_b64_tr_b16 v[30:31], v13 offset:6656
    v_mfma_f32_32x32x16_bf16 v[112:127], v[48:51], a[4:7], v[112:127]
    ds_read_b64_tr_b16 v[32:33], v14 offset:6144
    ds_read_b64_tr_b16 v[34:35], v14 offset:6656
    v_mfma_f32_32x32x16_bf16 v[128:143], v[52:55], a[4:7], v[128:143]
    ds_read_b64_tr_b16 v[36:37], v15 offset:6144
    ds_read_b64_tr_b16 v[38:39], v15 offset:6656
    s_waitcnt vmcnt(15)
    s_waitcnt lgkmcnt(8)
    v_mfma_f32_32x32x16_bf16 v[80:95], v[56:59], a[8:11], v[80:95]
    ds_read_b64_tr_b16 v[40:41], v12 offset:8192
    ds_read_b64_tr_b16 v[42:43], v12 offset:8704
    v_mfma_f32_32x32x16_bf16 v[96:111], v[60:63], a[8:11], v[96:111]
    ds_read_b64_tr_b16 v[44:45], v13 offset:8192
    ds_read_b64_tr_b16 v[46:47], v13 offset:8704
    buffer_load_dwordx4 a[72:75], v253, s[12:15], s17 offen offset:2048 sc1
    buffer_load_dwordx4 a[76:79], v253, s[12:15], s17 offen offset:3072 sc1
    s_add_u32 s17, s17, 4096
    v_mfma_f32_32x32x16_bf16 v[112:127], v[64:67], a[8:11], v[112:127]
    ds_read_b64_tr_b16 v[48:49], v14 offset:8192
    ds_read_b64_tr_b16 v[50:51], v14 offset:8704
    v_mfma_f32_32x32x16_bf16 v[128:143], v[68:71], a[8:11], v[128:143]
    ds_read_b64_tr_b16 v[52:53], v15 offset:8192
    ds_read_b64_tr_b16 v[54:55], v15 offset:8704
    s_waitcnt vmcnt(16)
    s_waitcnt lgkmcnt(8)
    v_mfma_f32_32x32x16_bf16 v[80:95], v[24:27], a[12:15], v[80:95]
    ds_read_b64_tr_b16 v[56:57], v12 offset:10240
    ds_read_b64_tr_b16 v[58:59], v12 offset:10752
    v_mfma_f32_32x32x16_bf16 v[96:111], v[28:31], a[12:15], v[96:111]
    ds_read_b64_tr_b16 v[60:61], v13 offset:10240
    ds_read_b64_tr_b16 v[62:63], v13 offset:10752
    v_mfma_f32_32x32x16_bf16 v[112:127], v[32:35], a[12:15], v[112:127]
    ds_read_b64_tr_b16 v[64:65], v14 offset:10240
    ds_read_b64_tr_b16 v[66:67], v14 offset:10752
    v_mfma_f32_32x32x16_bf16 v[128:143], v[36:39], a[12:15], v[128:143]
    ds_read_b64_tr_b16 v[68:69], v15 offset:10240
    ds_read_b64_tr_b16 v[70:71], v15 offset:10752
    s_waitcnt vmcnt(15)
    s_waitcnt lgkmcnt(8)
    v_mfma_f32_32x32x16_bf16 v[80:95], v[40:43], a[16:19], v[80:95]
    ds_read_b64_tr_b16 v[24:25], v12 offset:12288
    ds_read_b64_tr_b16 v[26:27], v12 offset:12800
    v_mfma_f32_32x32x16_bf16 v[96:111], v[44:47], a[16:19], v[96:111]
    ds_read_b64_tr_b16 v[28:29], v13 offset:12288
    ds_read_b64_tr_b16 v[30:31], v13 offset:12800
    buffer_load_dwordx4 a[80:83], v253, s[12:15], s17 offen offset:0 sc1
    buffer_load_dwordx4 a[84:87], v253, s[12:15], s17 offen offset:1024 sc1
    v_mfma_f32_32x32x16_bf16 v[112:127], v[48:51], a[16:19], v[112:127]
    ds_read_b64_tr_b16 v[32:33], v14 offset:12288
    ds_read_b64_tr_b16 v[34:35], v14 offset:12800
    v_mfma_f32_32x32x16_bf16 v[128:143], v[52:55], a[16:19], v[128:143]
    ds_read_b64_tr_b16 v[36:37], v15 offset:12288
    ds_read_b64_tr_b16 v[38:39], v15 offset:12800
    s_waitcnt vmcnt(16)
    s_waitcnt lgkmcnt(8)
    v_mfma_f32_32x32x16_bf16 v[80:95], v[56:59], a[20:23], v[80:95]
    ds_read_b64_tr_b16 v[40:41], v12 offset:14336
    ds_read_b64_tr_b16 v[42:43], v12 offset:14848
    s_add_u32 m0, s63, 0
    v_mfma_f32_32x32x16_bf16 v[96:111], v[60:63], a[20:23], v[96:111]
    ds_read_b64_tr_b16 v[44:45], v13 offset:14336
    ds_read_b64_tr_b16 v[46:47], v13 offset:14848
    buffer_load_dwordx4 v245, s[32:35], s62 offen offset:0 lds
    buffer_load_dwordx4 v246, s[32:35], s62 offen offset:1024 lds
    buffer_load_dwordx4 v247, s[32:35], s62 offen offset:2048 lds
    s_add_u32 s62, s62, 114688
    v_mfma_f32_32x32x16_bf16 v[112:127], v[64:67], a[20:23], v[112:127]
    ds_read_b64_tr_b16 v[48:49], v14 offset:14336
    ds_read_b64_tr_b16 v[50:51], v14 offset:14848
    v_mfma_f32_32x32x16_bf16 v[128:143], v[68:71], a[20:23], v[128:143]
    ds_read_b64_tr_b16 v[52:53], v15 offset:14336
    ds_read_b64_tr_b16 v[54:55], v15 offset:14848
    s_waitcnt vmcnt(18)
    s_waitcnt lgkmcnt(8)
    v_mfma_f32_32x32x16_bf16 v[80:95], v[24:27], a[24:27], v[80:95]
    ds_read_b64_tr_b16 v[56:57], v12 offset:16384
    ds_read_b64_tr_b16 v[58:59], v12 offset:16896
    v_mfma_f32_32x32x16_bf16 v[96:111], v[28:31], a[24:27], v[96:111]
    ds_read_b64_tr_b16 v[60:61], v13 offset:16384
    ds_read_b64_tr_b16 v[62:63], v13 offset:16896
    buffer_load_dwordx4 a[88:91], v253, s[12:15], s17 offen offset:2048 sc1
    buffer_load_dwordx4 a[92:95], v253, s[12:15], s17 offen offset:3072 sc1
    s_add_u32 s17, s17, 4096
    v_mfma_f32_32x32x16_bf16 v[112:127], v[32:35], a[24:27], v[112:127]
    ds_read_b64_tr_b16 v[64:65], v14 offset:16384
    ds_read_b64_tr_b16 v[66:67], v14 offset:16896
    v_mfma_f32_32x32x16_bf16 v[128:143], v[36:39], a[24:27], v[128:143]
    ds_read_b64_tr_b16 v[68:69], v15 offset:16384
    ds_read_b64_tr_b16 v[70:71], v15 offset:16896
    s_waitcnt vmcnt(19)
    s_waitcnt lgkmcnt(8)
    v_mfma_f32_32x32x16_bf16 v[80:95], v[40:43], a[28:31], v[80:95]
    ds_read_b64_tr_b16 v[24:25], v12 offset:18432
    ds_read_b64_tr_b16 v[26:27], v12 offset:18944
    s_add_u32 m0, s63, 3072
    v_mfma_f32_32x32x16_bf16 v[96:111], v[44:47], a[28:31], v[96:111]
    ds_read_b64_tr_b16 v[28:29], v13 offset:18432
    ds_read_b64_tr_b16 v[30:31], v13 offset:18944
    buffer_load_dwordx4 v245, s[32:35], s62 offen offset:0 lds
    buffer_load_dwordx4 v246, s[32:35], s62 offen offset:1024 lds
    buffer_load_dwordx4 v247, s[32:35], s62 offen offset:2048 lds
    s_add_u32 s62, s62, 344064
    v_mfma_f32_32x32x16_bf16 v[112:127], v[48:51], a[28:31], v[112:127]
    ds_read_b64_tr_b16 v[32:33], v14 offset:18432
    ds_read_b64_tr_b16 v[34:35], v14 offset:18944
    v_mfma_f32_32x32x16_bf16 v[128:143], v[52:55], a[28:31], v[128:143]
    ds_read_b64_tr_b16 v[36:37], v15 offset:18432
    ds_read_b64_tr_b16 v[38:39], v15 offset:18944
    s_waitcnt vmcnt(21)
    s_barrier
    s_waitcnt lgkmcnt(8)
    v_mfma_f32_32x32x16_bf16 v[80:95], v[56:59], a[32:35], v[80:95]
    ds_read_b64_tr_b16 v[40:41], v12 offset:20480
    ds_read_b64_tr_b16 v[42:43], v12 offset:20992
    v_mfma_f32_32x32x16_bf16 v[96:111], v[60:63], a[32:35], v[96:111]
    ds_read_b64_tr_b16 v[44:45], v13 offset:20480
    ds_read_b64_tr_b16 v[46:47], v13 offset:20992
    buffer_load_dwordx4 a[96:99], v253, s[12:15], s17 offen offset:0 sc1
    buffer_load_dwordx4 a[100:103], v253, s[12:15], s17 offen offset:1024 sc1
    v_mfma_f32_32x32x16_bf16 v[112:127], v[64:67], a[32:35], v[112:127]
    ds_read_b64_tr_b16 v[48:49], v14 offset:20480
    ds_read_b64_tr_b16 v[50:51], v14 offset:20992
    v_mfma_f32_32x32x16_bf16 v[128:143], v[68:71], a[32:35], v[128:143]
    ds_read_b64_tr_b16 v[52:53], v15 offset:20480
    ds_read_b64_tr_b16 v[54:55], v15 offset:20992
    s_waitcnt vmcnt(22)
    s_waitcnt lgkmcnt(8)
    v_mfma_f32_32x32x16_bf16 v[80:95], v[24:27], a[36:39], v[80:95]
    ds_read_b64_tr_b16 v[56:57], v12 offset:22528
    ds_read_b64_tr_b16 v[58:59], v12 offset:23040
    v_mfma_f32_32x32x16_bf16 v[96:111], v[28:31], a[36:39], v[96:111]
    ds_read_b64_tr_b16 v[60:61], v13 offset:22528
    ds_read_b64_tr_b16 v[62:63], v13 offset:23040
    v_mfma_f32_32x32x16_bf16 v[112:127], v[32:35], a[36:39], v[112:127]
    ds_read_b64_tr_b16 v[64:65], v14 offset:22528
    ds_read_b64_tr_b16 v[66:67], v14 offset:23040
    v_mfma_f32_32x32x16_bf16 v[128:143], v[36:39], a[36:39], v[128:143]
    ds_read_b64_tr_b16 v[68:69], v15 offset:22528
    ds_read_b64_tr_b16 v[70:71], v15 offset:23040
    s_waitcnt vmcnt(21)
    s_waitcnt lgkmcnt(8)
    v_mfma_f32_32x32x16_bf16 v[80:95], v[40:43], a[40:43], v[80:95]
    ds_read_b64_tr_b16 v[24:25], v12 offset:24576
    ds_read_b64_tr_b16 v[26:27], v12 offset:25088
    v_mfma_f32_32x32x16_bf16 v[96:111], v[44:47], a[40:43], v[96:111]
    ds_read_b64_tr_b16 v[28:29], v13 offset:24576
    ds_read_b64_tr_b16 v[30:31], v13 offset:25088
    buffer_load_dwordx4 a[104:107], v253, s[12:15], s17 offen offset:2048 sc1
    buffer_load_dwordx4 a[108:111], v253, s[12:15], s17 offen offset:3072 sc1
    s_add_u32 s17, s17, 4096
    v_mfma_f32_32x32x16_bf16 v[112:127], v[48:51], a[40:43], v[112:127]
    ds_read_b64_tr_b16 v[32:33], v14 offset:24576
    ds_read_b64_tr_b16 v[34:35], v14 offset:25088
    v_mfma_f32_32x32x16_bf16 v[128:143], v[52:55], a[40:43], v[128:143]
    ds_read_b64_tr_b16 v[36:37], v15 offset:24576
    ds_read_b64_tr_b16 v[38:39], v15 offset:25088
    s_waitcnt vmcnt(22)
    s_waitcnt lgkmcnt(8)
    v_mfma_f32_32x32x16_bf16 v[80:95], v[56:59], a[44:47], v[80:95]
    ds_read_b64_tr_b16 v[40:41], v12 offset:26624
    ds_read_b64_tr_b16 v[42:43], v12 offset:27136
    v_mfma_f32_32x32x16_bf16 v[96:111], v[60:63], a[44:47], v[96:111]
    ds_read_b64_tr_b16 v[44:45], v13 offset:26624
    ds_read_b64_tr_b16 v[46:47], v13 offset:27136
    v_mfma_f32_32x32x16_bf16 v[112:127], v[64:67], a[44:47], v[112:127]
    ds_read_b64_tr_b16 v[48:49], v14 offset:26624
    ds_read_b64_tr_b16 v[50:51], v14 offset:27136
    v_mfma_f32_32x32x16_bf16 v[128:143], v[68:71], a[44:47], v[128:143]
    ds_read_b64_tr_b16 v[52:53], v15 offset:26624
    ds_read_b64_tr_b16 v[54:55], v15 offset:27136
    s_waitcnt vmcnt(21)
    s_waitcnt lgkmcnt(8)
    v_mfma_f32_32x32x16_bf16 v[80:95], v[24:27], a[48:51], v[80:95]
    ds_read_b64_tr_b16 v[56:57], v12 offset:28672
    ds_read_b64_tr_b16 v[58:59], v12 offset:29184
    v_mfma_f32_32x32x16_bf16 v[96:111], v[28:31], a[48:51], v[96:111]
    ds_read_b64_tr_b16 v[60:61], v13 offset:28672
    ds_read_b64_tr_b16 v[62:63], v13 offset:29184
    buffer_load_dwordx4 a[112:115], v253, s[12:15], s17 offen offset:0 sc1
    buffer_load_dwordx4 a[116:119], v253, s[12:15], s17 offen offset:1024 sc1
    v_mfma_f32_32x32x16_bf16 v[112:127], v[32:35], a[48:51], v[112:127]
    ds_read_b64_tr_b16 v[64:65], v14 offset:28672
    ds_read_b64_tr_b16 v[66:67], v14 offset:29184
    v_mfma_f32_32x32x16_bf16 v[128:143], v[36:39], a[48:51], v[128:143]
    ds_read_b64_tr_b16 v[68:69], v15 offset:28672
    ds_read_b64_tr_b16 v[70:71], v15 offset:29184
    s_waitcnt vmcnt(22)
    s_waitcnt lgkmcnt(8)
    v_mfma_f32_32x32x16_bf16 v[80:95], v[40:43], a[52:55], v[80:95]
    ds_read_b64_tr_b16 v[24:25], v12 offset:30720
    ds_read_b64_tr_b16 v[26:27], v12 offset:31232
    s_add_u32 m0, s37, 0
    v_mfma_f32_32x32x16_bf16 v[96:111], v[44:47], a[52:55], v[96:111]
    ds_read_b64_tr_b16 v[28:29], v13 offset:30720
    ds_read_b64_tr_b16 v[30:31], v13 offset:31232
    buffer_load_dwordx4 v245, s[32:35], s62 offen offset:0 lds
    buffer_load_dwordx4 v246, s[32:35], s62 offen offset:1024 lds
    buffer_load_dwordx4 v247, s[32:35], s62 offen offset:2048 lds
    s_add_u32 s62, s62, 114688
    v_mfma_f32_32x32x16_bf16 v[112:127], v[48:51], a[52:55], v[112:127]
    ds_read_b64_tr_b16 v[32:33], v14 offset:30720
    ds_read_b64_tr_b16 v[34:35], v14 offset:31232
    v_mfma_f32_32x32x16_bf16 v[128:143], v[52:55], a[52:55], v[128:143]
    ds_read_b64_tr_b16 v[36:37], v15 offset:30720
    ds_read_b64_tr_b16 v[38:39], v15 offset:31232
    s_waitcnt vmcnt(24)
    s_waitcnt lgkmcnt(8)
    v_mfma_f32_32x32x16_bf16 v[80:95], v[56:59], a[56:59], v[80:95]
    ds_read_b64_tr_b16 v[40:41], v12 offset:32768
    ds_read_b64_tr_b16 v[42:43], v12 offset:33280
    v_mfma_f32_32x32x16_bf16 v[96:111], v[60:63], a[56:59], v[96:111]
    ds_read_b64_tr_b16 v[44:45], v13 offset:32768
    ds_read_b64_tr_b16 v[46:47], v13 offset:33280
    buffer_load_dwordx4 a[120:123], v253, s[12:15], s17 offen offset:2048 sc1
    buffer_load_dwordx4 a[124:127], v253, s[12:15], s17 offen offset:3072 sc1
    v_mfma_f32_32x32x16_bf16 v[112:127], v[64:67], a[56:59], v[112:127]
    ds_read_b64_tr_b16 v[48:49], v14 offset:32768
    ds_read_b64_tr_b16 v[50:51], v14 offset:33280
    v_mfma_f32_32x32x16_bf16 v[128:143], v[68:71], a[56:59], v[128:143]
    ds_read_b64_tr_b16 v[52:53], v15 offset:32768
    ds_read_b64_tr_b16 v[54:55], v15 offset:33280
    s_waitcnt vmcnt(25)
    s_waitcnt lgkmcnt(8)
    v_mfma_f32_32x32x16_bf16 v[80:95], v[24:27], a[60:63], v[80:95]
    ds_read_b64_tr_b16 v[56:57], v12 offset:34816
    ds_read_b64_tr_b16 v[58:59], v12 offset:35328
    v_mfma_f32_32x32x16_bf16 v[96:111], v[28:31], a[60:63], v[96:111]
    ds_read_b64_tr_b16 v[60:61], v13 offset:34816
    ds_read_b64_tr_b16 v[62:63], v13 offset:35328
    v_mfma_f32_32x32x16_bf16 v[112:127], v[32:35], a[60:63], v[112:127]
    ds_read_b64_tr_b16 v[64:65], v14 offset:34816
    ds_read_b64_tr_b16 v[66:67], v14 offset:35328
    v_mfma_f32_32x32x16_bf16 v[128:143], v[36:39], a[60:63], v[128:143]
    ds_read_b64_tr_b16 v[68:69], v15 offset:34816
    ds_read_b64_tr_b16 v[70:71], v15 offset:35328
    s_waitcnt vmcnt(24)
    s_barrier
    s_waitcnt lgkmcnt(8)
    v_mfma_f32_32x32x16_bf16 v[80:95], v[40:43], a[64:67], v[80:95]
    ds_read_b64_tr_b16 v[24:25], v12 offset:36864
    ds_read_b64_tr_b16 v[26:27], v12 offset:37376
    v_mfma_f32_32x32x16_bf16 v[96:111], v[44:47], a[64:67], v[96:111]
    ds_read_b64_tr_b16 v[28:29], v13 offset:36864
    ds_read_b64_tr_b16 v[30:31], v13 offset:37376
    v_mfma_f32_32x32x16_bf16 v[112:127], v[48:51], a[64:67], v[112:127]
    ds_read_b64_tr_b16 v[32:33], v14 offset:36864
    ds_read_b64_tr_b16 v[34:35], v14 offset:37376
    v_mfma_f32_32x32x16_bf16 v[128:143], v[52:55], a[64:67], v[128:143]
    ds_read_b64_tr_b16 v[36:37], v15 offset:36864
    ds_read_b64_tr_b16 v[38:39], v15 offset:37376
    s_waitcnt vmcnt(23)
    s_waitcnt lgkmcnt(8)
    v_mfma_f32_32x32x16_bf16 v[80:95], v[56:59], a[68:71], v[80:95]
    ds_read_b64_tr_b16 v[40:41], v12 offset:38912
    ds_read_b64_tr_b16 v[42:43], v12 offset:39424
    s_add_u32 m0, s37, 3072
    v_mfma_f32_32x32x16_bf16 v[96:111], v[60:63], a[68:71], v[96:111]
    ds_read_b64_tr_b16 v[44:45], v13 offset:38912
    ds_read_b64_tr_b16 v[46:47], v13 offset:39424
    buffer_load_dwordx4 v245, s[32:35], s62 offen offset:0 lds
    buffer_load_dwordx4 v246, s[32:35], s62 offen offset:1024 lds
    buffer_load_dwordx4 v247, s[32:35], s62 offen offset:2048 lds
    s_add_u32 s62, s62, 344064
    v_mfma_f32_32x32x16_bf16 v[112:127], v[64:67], a[68:71], v[112:127]
    ds_read_b64_tr_b16 v[48:49], v14 offset:38912
    ds_read_b64_tr_b16 v[50:51], v14 offset:39424
    v_mfma_f32_32x32x16_bf16 v[128:143], v[68:71], a[68:71], v[128:143]
    ds_read_b64_tr_b16 v[52:53], v15 offset:38912
    ds_read_b64_tr_b16 v[54:55], v15 offset:39424
    s_waitcnt vmcnt(25)
    s_waitcnt lgkmcnt(8)
    v_mfma_f32_32x32x16_bf16 v[80:95], v[24:27], a[72:75], v[80:95]
    ds_read_b64_tr_b16 v[56:57], v12 offset:40960
    ds_read_b64_tr_b16 v[58:59], v12 offset:41472
    v_mfma_f32_32x32x16_bf16 v[96:111], v[28:31], a[72:75], v[96:111]
    ds_read_b64_tr_b16 v[60:61], v13 offset:40960
    ds_read_b64_tr_b16 v[62:63], v13 offset:41472
    v_mfma_f32_32x32x16_bf16 v[112:127], v[32:35], a[72:75], v[112:127]
    ds_read_b64_tr_b16 v[64:65], v14 offset:40960
    ds_read_b64_tr_b16 v[66:67], v14 offset:41472
    v_mfma_f32_32x32x16_bf16 v[128:143], v[36:39], a[72:75], v[128:143]
    ds_read_b64_tr_b16 v[68:69], v15 offset:40960
    ds_read_b64_tr_b16 v[70:71], v15 offset:41472
    s_waitcnt vmcnt(24)
    s_waitcnt lgkmcnt(8)
    v_mfma_f32_32x32x16_bf16 v[80:95], v[40:43], a[76:79], v[80:95]
    ds_read_b64_tr_b16 v[24:25], v12 offset:43008
    ds_read_b64_tr_b16 v[26:27], v12 offset:43520
    v_mfma_f32_32x32x16_bf16 v[96:111], v[44:47], a[76:79], v[96:111]
    ds_read_b64_tr_b16 v[28:29], v13 offset:43008
    ds_read_b64_tr_b16 v[30:31], v13 offset:43520
    v_mfma_f32_32x32x16_bf16 v[112:127], v[48:51], a[76:79], v[112:127]
    ds_read_b64_tr_b16 v[32:33], v14 offset:43008
    ds_read_b64_tr_b16 v[34:35], v14 offset:43520
    v_mfma_f32_32x32x16_bf16 v[128:143], v[52:55], a[76:79], v[128:143]
    ds_read_b64_tr_b16 v[36:37], v15 offset:43008
    ds_read_b64_tr_b16 v[38:39], v15 offset:43520
    s_waitcnt vmcnt(23)
    s_waitcnt lgkmcnt(8)
    v_mfma_f32_32x32x16_bf16 v[80:95], v[56:59], a[80:83], v[80:95]
    ds_read_b64_tr_b16 v[40:41], v12 offset:45056
    ds_read_b64_tr_b16 v[42:43], v12 offset:45568
    v_mfma_f32_32x32x16_bf16 v[96:111], v[60:63], a[80:83], v[96:111]
    ds_read_b64_tr_b16 v[44:45], v13 offset:45056
    ds_read_b64_tr_b16 v[46:47], v13 offset:45568
    v_mfma_f32_32x32x16_bf16 v[112:127], v[64:67], a[80:83], v[112:127]
    ds_read_b64_tr_b16 v[48:49], v14 offset:45056
    ds_read_b64_tr_b16 v[50:51], v14 offset:45568
    v_mfma_f32_32x32x16_bf16 v[128:143], v[68:71], a[80:83], v[128:143]
    ds_read_b64_tr_b16 v[52:53], v15 offset:45056
    ds_read_b64_tr_b16 v[54:55], v15 offset:45568
    s_waitcnt vmcnt(22)
    s_waitcnt lgkmcnt(8)
    v_mfma_f32_32x32x16_bf16 v[80:95], v[24:27], a[84:87], v[80:95]
    ds_read_b64_tr_b16 v[56:57], v12 offset:47104
    ds_read_b64_tr_b16 v[58:59], v12 offset:47616
    v_mfma_f32_32x32x16_bf16 v[96:111], v[28:31], a[84:87], v[96:111]
    ds_read_b64_tr_b16 v[60:61], v13 offset:47104
    ds_read_b64_tr_b16 v[62:63], v13 offset:47616
    v_mfma_f32_32x32x16_bf16 v[112:127], v[32:35], a[84:87], v[112:127]
    ds_read_b64_tr_b16 v[64:65], v14 offset:47104
    ds_read_b64_tr_b16 v[66:67], v14 offset:47616
    v_mfma_f32_32x32x16_bf16 v[128:143], v[36:39], a[84:87], v[128:143]
    ds_read_b64_tr_b16 v[68:69], v15 offset:47104
    ds_read_b64_tr_b16 v[70:71], v15 offset:47616
    s_waitcnt vmcnt(18)
    s_waitcnt lgkmcnt(8)
    v_mfma_f32_32x32x16_bf16 v[80:95], v[40:43], a[88:91], v[80:95]
    ds_read_b64_tr_b16 v[24:25], v12 offset:49152
    ds_read_b64_tr_b16 v[26:27], v12 offset:49664
    v_mfma_f32_32x32x16_bf16 v[96:111], v[44:47], a[88:91], v[96:111]
    ds_read_b64_tr_b16 v[28:29], v13 offset:49152
    ds_read_b64_tr_b16 v[30:31], v13 offset:49664
    v_mfma_f32_32x32x16_bf16 v[112:127], v[48:51], a[88:91], v[112:127]
    ds_read_b64_tr_b16 v[32:33], v14 offset:49152
    ds_read_b64_tr_b16 v[34:35], v14 offset:49664
    v_mfma_f32_32x32x16_bf16 v[128:143], v[52:55], a[88:91], v[128:143]
    ds_read_b64_tr_b16 v[36:37], v15 offset:49152
    ds_read_b64_tr_b16 v[38:39], v15 offset:49664
    s_waitcnt vmcnt(17)
    s_waitcnt lgkmcnt(8)
    v_mfma_f32_32x32x16_bf16 v[80:95], v[56:59], a[92:95], v[80:95]
    ds_read_b64_tr_b16 v[40:41], v12 offset:51200
    ds_read_b64_tr_b16 v[42:43], v12 offset:51712
    s_add_u32 m0, s37, 16384
    v_mfma_f32_32x32x16_bf16 v[96:111], v[60:63], a[92:95], v[96:111]
    ds_read_b64_tr_b16 v[44:45], v13 offset:51200
    ds_read_b64_tr_b16 v[46:47], v13 offset:51712
    buffer_load_dwordx4 v245, s[32:35], s62 offen offset:0 lds
    buffer_load_dwordx4 v246, s[32:35], s62 offen offset:1024 lds
    buffer_load_dwordx4 v247, s[32:35], s62 offen offset:2048 lds
    s_add_u32 s62, s62, 114688
    v_mfma_f32_32x32x16_bf16 v[112:127], v[64:67], a[92:95], v[112:127]
    ds_read_b64_tr_b16 v[48:49], v14 offset:51200
    ds_read_b64_tr_b16 v[50:51], v14 offset:51712
    v_mfma_f32_32x32x16_bf16 v[128:143], v[68:71], a[92:95], v[128:143]
    ds_read_b64_tr_b16 v[52:53], v15 offset:51200
    ds_read_b64_tr_b16 v[54:55], v15 offset:51712
    s_waitcnt vmcnt(16)
    s_barrier
    s_waitcnt lgkmcnt(8)
    v_mfma_f32_32x32x16_bf16 v[80:95], v[24:27], a[96:99], v[80:95]
    ds_read_b64_tr_b16 v[56:57], v12 offset:53248
    ds_read_b64_tr_b16 v[58:59], v12 offset:53760
    v_mfma_f32_32x32x16_bf16 v[96:111], v[28:31], a[96:99], v[96:111]
    ds_read_b64_tr_b16 v[60:61], v13 offset:53248
    ds_read_b64_tr_b16 v[62:63], v13 offset:53760
    v_mfma_f32_32x32x16_bf16 v[112:127], v[32:35], a[96:99], v[112:127]
    ds_read_b64_tr_b16 v[64:65], v14 offset:53248
    ds_read_b64_tr_b16 v[66:67], v14 offset:53760
    v_mfma_f32_32x32x16_bf16 v[128:143], v[36:39], a[96:99], v[128:143]
    ds_read_b64_tr_b16 v[68:69], v15 offset:53248
    ds_read_b64_tr_b16 v[70:71], v15 offset:53760
    s_waitcnt vmcnt(15)
    s_waitcnt lgkmcnt(8)
    v_mfma_f32_32x32x16_bf16 v[80:95], v[40:43], a[100:103], v[80:95]
    ds_read_b64_tr_b16 v[24:25], v12 offset:55296
    ds_read_b64_tr_b16 v[26:27], v12 offset:55808
    v_mfma_f32_32x32x16_bf16 v[96:111], v[44:47], a[100:103], v[96:111]
    ds_read_b64_tr_b16 v[28:29], v13 offset:55296
    ds_read_b64_tr_b16 v[30:31], v13 offset:55808
    v_mfma_f32_32x32x16_bf16 v[112:127], v[48:51], a[100:103], v[112:127]
    ds_read_b64_tr_b16 v[32:33], v14 offset:55296
    ds_read_b64_tr_b16 v[34:35], v14 offset:55808
    v_mfma_f32_32x32x16_bf16 v[128:143], v[52:55], a[100:103], v[128:143]
    ds_read_b64_tr_b16 v[36:37], v15 offset:55296
    ds_read_b64_tr_b16 v[38:39], v15 offset:55808
    s_waitcnt vmcnt(14)
    s_waitcnt lgkmcnt(8)
    v_mfma_f32_32x32x16_bf16 v[80:95], v[56:59], a[104:107], v[80:95]
    ds_read_b64_tr_b16 v[40:41], v12 offset:57344
    ds_read_b64_tr_b16 v[42:43], v12 offset:57856
    v_mfma_f32_32x32x16_bf16 v[96:111], v[60:63], a[104:107], v[96:111]
    ds_read_b64_tr_b16 v[44:45], v13 offset:57344
    ds_read_b64_tr_b16 v[46:47], v13 offset:57856
    v_mfma_f32_32x32x16_bf16 v[112:127], v[64:67], a[104:107], v[112:127]
    ds_read_b64_tr_b16 v[48:49], v14 offset:57344
    ds_read_b64_tr_b16 v[50:51], v14 offset:57856
    v_mfma_f32_32x32x16_bf16 v[128:143], v[68:71], a[104:107], v[128:143]
    ds_read_b64_tr_b16 v[52:53], v15 offset:57344
    ds_read_b64_tr_b16 v[54:55], v15 offset:57856
    s_waitcnt vmcnt(13)
    s_waitcnt lgkmcnt(8)
    v_mfma_f32_32x32x16_bf16 v[80:95], v[24:27], a[108:111], v[80:95]
    ds_read_b64_tr_b16 v[56:57], v12 offset:59392
    ds_read_b64_tr_b16 v[58:59], v12 offset:59904
    s_add_u32 m0, s37, 19456
    v_mfma_f32_32x32x16_bf16 v[96:111], v[28:31], a[108:111], v[96:111]
    ds_read_b64_tr_b16 v[60:61], v13 offset:59392
    ds_read_b64_tr_b16 v[62:63], v13 offset:59904
    buffer_load_dwordx4 v245, s[32:35], s62 offen offset:0 lds
    buffer_load_dwordx4 v246, s[32:35], s62 offen offset:1024 lds
    buffer_load_dwordx4 v247, s[32:35], s62 offen offset:2048 lds
    s_add_u32 s62, s62, 344064
    v_mfma_f32_32x32x16_bf16 v[112:127], v[32:35], a[108:111], v[112:127]
    ds_read_b64_tr_b16 v[64:65], v14 offset:59392
    ds_read_b64_tr_b16 v[66:67], v14 offset:59904
    v_mfma_f32_32x32x16_bf16 v[128:143], v[36:39], a[108:111], v[128:143]
    ds_read_b64_tr_b16 v[68:69], v15 offset:59392
    ds_read_b64_tr_b16 v[70:71], v15 offset:59904
    s_waitcnt vmcnt(15)
    s_waitcnt lgkmcnt(8)
    v_mfma_f32_32x32x16_bf16 v[80:95], v[40:43], a[112:115], v[80:95]
    ds_read_b64_tr_b16 v[24:25], v12 offset:61440
    ds_read_b64_tr_b16 v[26:27], v12 offset:61952
    v_mfma_f32_32x32x16_bf16 v[96:111], v[44:47], a[112:115], v[96:111]
    ds_read_b64_tr_b16 v[28:29], v13 offset:61440
    ds_read_b64_tr_b16 v[30:31], v13 offset:61952
    v_mfma_f32_32x32x16_bf16 v[112:127], v[48:51], a[112:115], v[112:127]
    ds_read_b64_tr_b16 v[32:33], v14 offset:61440
    ds_read_b64_tr_b16 v[34:35], v14 offset:61952
    v_mfma_f32_32x32x16_bf16 v[128:143], v[52:55], a[112:115], v[128:143]
    ds_read_b64_tr_b16 v[36:37], v15 offset:61440
    ds_read_b64_tr_b16 v[38:39], v15 offset:61952
    s_waitcnt vmcnt(14)
    s_waitcnt lgkmcnt(8)
    v_mfma_f32_32x32x16_bf16 v[80:95], v[56:59], a[116:119], v[80:95]
    ds_read_b64_tr_b16 v[40:41], v12 offset:63488
    ds_read_b64_tr_b16 v[42:43], v12 offset:64000
    v_mfma_f32_32x32x16_bf16 v[96:111], v[60:63], a[116:119], v[96:111]
    ds_read_b64_tr_b16 v[44:45], v13 offset:63488
    ds_read_b64_tr_b16 v[46:47], v13 offset:64000
    v_mfma_f32_32x32x16_bf16 v[112:127], v[64:67], a[116:119], v[112:127]
    ds_read_b64_tr_b16 v[48:49], v14 offset:63488
    ds_read_b64_tr_b16 v[50:51], v14 offset:64000
    v_mfma_f32_32x32x16_bf16 v[128:143], v[68:71], a[116:119], v[128:143]
    ds_read_b64_tr_b16 v[52:53], v15 offset:63488
    ds_read_b64_tr_b16 v[54:55], v15 offset:64000
    s_waitcnt vmcnt(10)
    s_waitcnt lgkmcnt(8)
    v_mfma_f32_32x32x16_bf16 v[80:95], v[24:27], a[120:123], v[80:95]
    ds_read_b64_tr_b16 v[56:57], v16 offset:0
    ds_read_b64_tr_b16 v[58:59], v16 offset:384
    v_mfma_f32_32x32x16_bf16 v[96:111], v[28:31], a[120:123], v[96:111]
    ds_read_b64_tr_b16 v[60:61], v16 offset:32
    ds_read_b64_tr_b16 v[62:63], v16 offset:416
    v_mfma_f32_32x32x16_bf16 v[112:127], v[32:35], a[120:123], v[112:127]
    ds_read_b64_tr_b16 v[64:65], v16 offset:64
    v_mfma_f32_32x32x16_bf16 v[128:143], v[36:39], a[120:123], v[128:143]
    ds_read_b64_tr_b16 v[66:67], v16 offset:448
    s_waitcnt vmcnt(9)
    s_waitcnt lgkmcnt(6)
    v_mfma_f32_32x32x16_bf16 v[80:95], v[40:43], a[124:127], v[80:95]
    ds_read_b64_tr_b16 v[24:25], v16 offset:1536
    ds_read_b64_tr_b16 v[26:27], v16 offset:1920
    v_mfma_f32_32x32x16_bf16 v[96:111], v[44:47], a[124:127], v[96:111]
    ds_read_b64_tr_b16 v[28:29], v16 offset:1568
    ds_read_b64_tr_b16 v[30:31], v16 offset:1952
    v_mfma_f32_32x32x16_bf16 v[112:127], v[48:51], a[124:127], v[112:127]
    ds_read_b64_tr_b16 v[32:33], v16 offset:1600
    v_mfma_f32_32x32x16_bf16 v[128:143], v[52:55], a[124:127], v[128:143]
    ds_read_b64_tr_b16 v[34:35], v16 offset:1984
    s_waitcnt vmcnt(6)
    s_barrier
    s_waitcnt lgkmcnt(6)
    v_mfma_f32_32x32x16_bf16 v[144:159], v[56:59], a[0:3], 0
    ds_read_b64_tr_b16 v[40:41], v16 offset:3072
    ds_read_b64_tr_b16 v[42:43], v16 offset:3456
    s_add_u32 m0, s37, 32768
    v_mfma_f32_32x32x16_bf16 v[160:175], v[60:63], a[0:3], 0
    ds_read_b64_tr_b16 v[44:45], v16 offset:3104
    ds_read_b64_tr_b16 v[46:47], v16 offset:3488
    buffer_load_dwordx4 v245, s[32:35], s62 offen offset:0 lds
    buffer_load_dwordx4 v246, s[32:35], s62 offen offset:1024 lds
    buffer_load_dwordx4 v247, s[32:35], s62 offen offset:2048 lds
    s_add_u32 s62, s62, 114688
    v_mul_f32 v192, v80, v80
    v_mul_f32 v193, v81, v81
    v_mul_f32 v194, v82, v82
    v_mul_f32 v195, v83, v83
    v_fma_f32 v192, v192, s60, v18
    v_fma_f32 v193, v193, s60, v18
    v_fma_f32 v194, v194, s60, v18
    v_mfma_f32_32x32x16_bf16 v[176:191], v[64:67], a[0:3], 0
    ds_read_b64_tr_b16 v[48:49], v16 offset:3136
    ds_read_b64_tr_b16 v[50:51], v16 offset:3520
    v_fma_f32 v195, v195, s60, v18
    v_mul_f32 v192, v192, v80
    v_mul_f32 v193, v193, v81
    v_mul_f32 v194, v194, v82
    v_mul_f32 v195, v195, v83
    v_exp_f32 v192, v192
    v_mul_f32 v80, v80, v84
    s_waitcnt lgkmcnt(6)
    v_mfma_f32_32x32x16_bf16 v[144:159], v[24:27], a[4:7], v[144:159]
    ds_read_b64_tr_b16 v[56:57], v16 offset:4608
    ds_read_b64_tr_b16 v[58:59], v16 offset:4992
    v_exp_f32 v193, v193
    v_mul_f32 v81, v81, v85
    v_exp_f32 v194, v194
    v_mul_f32 v82, v82, v86
    v_exp_f32 v195, v195
    v_mul_f32 v83, v83, v87
    v_add_f32 v192, 1.0, v192
    s_add_u32 m0, s55, 49152
    v_mfma_f32_32x32x16_bf16 v[160:175], v[28:31], a[4:7], v[160:175]
    ds_read_b64_tr_b16 v[60:61], v16 offset:4640
    ds_read_b64_tr_b16 v[62:63], v16 offset:5024
    buffer_load_dwordx4 v251, s[40:43], s54 offen offset:0 lds
    buffer_load_dwordx4 v252, s[40:43], s54 offen offset:1024 lds
    s_add_u32 s54, s54, 16384
    v_add_f32 v193, 1.0, v193
    v_rcp_f32 v192, v192
    v_add_f32 v194, 1.0, v194
    v_rcp_f32 v193, v193
    v_add_f32 v195, 1.0, v195
    v_rcp_f32 v194, v194
    v_mul_f32 v80, v80, v192
    v_mfma_f32_32x32x16_bf16 v[176:191], v[32:35], a[4:7], v[176:191]
    ds_read_b64_tr_b16 v[64:65], v16 offset:4672
    ds_read_b64_tr_b16 v[66:67], v16 offset:5056
    v_rcp_f32 v195, v195
    v_mul_f32 v81, v81, v193
    v_mul_f32 v82, v82, v194
    v_mul_f32 v83, v83, v195
    v_cvt_pk_bf16_f32 v200, v80, v81
    v_cvt_pk_bf16_f32 v201, v82, v83
    v_mul_f32 v196, v88, v88
    s_waitcnt lgkmcnt(6)
    v_mfma_f32_32x32x16_bf16 v[144:159], v[40:43], a[8:11], v[144:159]
    ds_read_b64_tr_b16 v[24:25], v16 offset:6144
    ds_read_b64_tr_b16 v[26:27], v16 offset:6528
    v_mul_f32 v197, v89, v89
    v_mul_f32 v198, v90, v90
    v_mul_f32 v199, v91, v91
    v_fma_f32 v196, v196, s60, v18
    v_fma_f32 v197, v197, s60, v18
    v_fma_f32 v198, v198, s60, v18
    v_fma_f32 v199, v199, s60, v18
    s_add_u32 m0, s37, 35840
    v_mfma_f32_32x32x16_bf16 v[160:175], v[44:47], a[8:11], v[160:175]
    ds_read_b64_tr_b16 v[28:29], v16 offset:6176
    ds_read_b64_tr_b16 v[30:31], v16 offset:6560
    buffer_load_dwordx4 v245, s[32:35], s62 offen offset:0 lds
    buffer_load_dwordx4 v246, s[32:35], s62 offen offset:1024 lds
    buffer_load_dwordx4 v247, s[32:35], s62 offen offset:2048 lds
    s_add_u32 s62, s62, 344064
    v_mul_f32 v196, v196, v88
    v_mul_f32 v197, v197, v89
    v_mul_f32 v198, v198, v90
    v_mul_f32 v199, v199, v91
    v_exp_f32 v196, v196
    v_mul_f32 v88, v88, v92
    v_exp_f32 v197, v197
    v_mfma_f32_32x32x16_bf16 v[176:191], v[48:51], a[8:11], v[176:191]
    ds_read_b64_tr_b16 v[32:33], v16 offset:6208
    ds_read_b64_tr_b16 v[34:35], v16 offset:6592
    v_mul_f32 v89, v89, v93
    v_exp_f32 v198, v198
    v_mul_f32 v90, v90, v94
    v_exp_f32 v199, v199
    v_mul_f32 v91, v91, v95
    v_add_f32 v196, 1.0, v196
    v_add_f32 v197, 1.0, v197
    s_waitcnt lgkmcnt(6)
    v_mfma_f32_32x32x16_bf16 v[144:159], v[56:59], a[12:15], v[144:159]
    ds_read_b64_tr_b16 v[40:41], v16 offset:7680
    ds_read_b64_tr_b16 v[42:43], v16 offset:8064
    v_rcp_f32 v196, v196
    v_add_f32 v198, 1.0, v198
    v_rcp_f32 v197, v197
    v_add_f32 v199, 1.0, v199
    v_rcp_f32 v198, v198
    v_mul_f32 v88, v88, v196
    v_rcp_f32 v199, v199
    s_add_u32 m0, s55, 57344
    v_mfma_f32_32x32x16_bf16 v[160:175], v[60:63], a[12:15], v[160:175]
    ds_read_b64_tr_b16 v[44:45], v16 offset:7712
    ds_read_b64_tr_b16 v[46:47], v16 offset:8096
    buffer_load_dwordx4 v251, s[40:43], s54 offen offset:0 lds
    buffer_load_dwordx4 v252, s[40:43], s54 offen offset:1024 lds
    s_add_u32 s54, s54, 16384
    v_mul_f32 v89, v89, v197
    v_mul_f32 v90, v90, v198
    v_mul_f32 v91, v91, v199
    v_cvt_pk_bf16_f32 v202, v88, v89
    v_cvt_pk_bf16_f32 v203, v90, v91
    buffer_store_dwordx4 v[200:203], v253, s[12:15], s23 offen offset:0 sc1
    v_mul_f32 v192, v96, v96
    v_mfma_f32_32x32x16_bf16 v[176:191], v[64:67], a[12:15], v[176:191]
    ds_read_b64_tr_b16 v[48:49], v16 offset:7744
    ds_read_b64_tr_b16 v[50:51], v16 offset:8128
    v_mul_f32 v193, v97, v97
    v_mul_f32 v194, v98, v98
    v_mul_f32 v195, v99, v99
    v_fma_f32 v192, v192, s60, v18
    v_fma_f32 v193, v193, s60, v18
    v_fma_f32 v194, v194, s60, v18
    v_fma_f32 v195, v195, s60, v18
    s_waitcnt lgkmcnt(6)
    v_mfma_f32_32x32x16_bf16 v[144:159], v[24:27], a[16:19], v[144:159]
    ds_read_b64_tr_b16 v[56:57], v16 offset:9216
    ds_read_b64_tr_b16 v[58:59], v16 offset:9600
    v_mul_f32 v192, v192, v96
    v_mul_f32 v193, v193, v97
    v_mul_f32 v194, v194, v98
    v_mul_f32 v195, v195, v99
    v_exp_f32 v192, v192
    v_mul_f32 v96, v96, v100
    v_exp_f32 v193, v193
    v_mfma_f32_32x32x16_bf16 v[160:175], v[28:31], a[16:19], v[160:175]
    ds_read_b64_tr_b16 v[60:61], v16 offset:9248
    ds_read_b64_tr_b16 v[62:63], v16 offset:9632
    v_mul_f32 v97, v97, v101
    v_exp_f32 v194, v194
    v_mul_f32 v98, v98, v102
    v_exp_f32 v195, v195
    v_mul_f32 v99, v99, v103
    v_add_f32 v192, 1.0, v192
    v_add_f32 v193, 1.0, v193
    v_mfma_f32_32x32x16_bf16 v[176:191], v[32:35], a[16:19], v[176:191]
    ds_read_b64_tr_b16 v[64:65], v16 offset:9280
    ds_read_b64_tr_b16 v[66:67], v16 offset:9664
    v_rcp_f32 v192, v192
    v_add_f32 v194, 1.0, v194
    v_rcp_f32 v193, v193
    v_add_f32 v195, 1.0, v195
    v_rcp_f32 v194, v194
    v_mul_f32 v96, v96, v192
    v_rcp_f32 v195, v195
    s_waitcnt lgkmcnt(6)
    v_mfma_f32_32x32x16_bf16 v[144:159], v[40:43], a[20:23], v[144:159]
    ds_read_b64_tr_b16 v[24:25], v16 offset:10752
    ds_read_b64_tr_b16 v[26:27], v16 offset:11136
    v_mul_f32 v97, v97, v193
    v_mul_f32 v98, v98, v194
    v_mul_f32 v99, v99, v195
    v_cvt_pk_bf16_f32 v204, v96, v97
    v_cvt_pk_bf16_f32 v205, v98, v99
    v_mul_f32 v196, v104, v104
    v_mul_f32 v197, v105, v105
    s_add_u32 m0, s55, 114688
    v_mfma_f32_32x32x16_bf16 v[160:175], v[44:47], a[20:23], v[160:175]
    ds_read_b64_tr_b16 v[28:29], v16 offset:10784
    ds_read_b64_tr_b16 v[30:31], v16 offset:11168
    buffer_load_dwordx4 v251, s[40:43], s54 offen offset:0 lds
    buffer_load_dwordx4 v252, s[40:43], s54 offen offset:1024 lds
    s_add_u32 s54, s54, 16384
    v_mul_f32 v198, v106, v106
    v_mul_f32 v199, v107, v107
    v_fma_f32 v196, v196, s60, v18
    v_fma_f32 v197, v197, s60, v18
    v_fma_f32 v198, v198, s60, v18
    v_fma_f32 v199, v199, s60, v18
    v_mul_f32 v196, v196, v104
    v_mfma_f32_32x32x16_bf16 v[176:191], v[48:51], a[20:23], v[176:191]
    ds_read_b64_tr_b16 v[32:33], v16 offset:10816
    ds_read_b64_tr_b16 v[34:35], v16 offset:11200
    v_mul_f32 v197, v197, v105
    v_mul_f32 v198, v198, v106
    v_mul_f32 v199, v199, v107
    v_exp_f32 v196, v196
    v_mul_f32 v104, v104, v108
    v_exp_f32 v197, v197
    v_mul_f32 v105, v105, v109
    s_waitcnt lgkmcnt(6)
    v_mfma_f32_32x32x16_bf16 v[144:159], v[56:59], a[24:27], v[144:159]
    ds_read_b64_tr_b16 v[40:41], v17 offset:0
    ds_read_b64_tr_b16 v[42:43], v17 offset:384
    v_exp_f32 v198, v198
    v_mul_f32 v106, v106, v110
    v_exp_f32 v199, v199
    v_mul_f32 v107, v107, v111
    v_add_f32 v196, 1.0, v196
    v_add_f32 v197, 1.0, v197
    v_rcp_f32 v196, v196
    v_mfma_f32_32x32x16_bf16 v[160:175], v[60:63], a[24:27], v[160:175]
    ds_read_b64_tr_b16 v[44:45], v17 offset:32
    ds_read_b64_tr_b16 v[46:47], v17 offset:416
    v_add_f32 v198, 1.0, v198
    v_rcp_f32 v197, v197
    v_add_f32 v199, 1.0, v199
    v_rcp_f32 v198, v198
    v_mul_f32 v104, v104, v196
    v_rcp_f32 v199, v199
    v_mul_f32 v105, v105, v197
    v_mfma_f32_32x32x16_bf16 v[176:191], v[64:67], a[24:27], v[176:191]
    ds_read_b64_tr_b16 v[48:49], v17 offset:64
    ds_read_b64_tr_b16 v[50:51], v17 offset:448
    v_mul_f32 v106, v106, v198
    v_mul_f32 v107, v107, v199
    v_cvt_pk_bf16_f32 v206, v104, v105
    v_cvt_pk_bf16_f32 v207, v106, v107
    buffer_store_dwordx4 v[204:207], v253, s[12:15], s23 offen offset:1024 sc1
    v_mul_f32 v192, v112, v112
    v_mul_f32 v193, v113, v113
    s_waitcnt lgkmcnt(6)
    v_mfma_f32_32x32x16_bf16 v[144:159], v[24:27], a[28:31], v[144:159]
    ds_read_b64_tr_b16 v[56:57], v17 offset:1536
    ds_read_b64_tr_b16 v[58:59], v17 offset:1920
    v_mul_f32 v194, v114, v114
    v_mul_f32 v195, v115, v115
    v_fma_f32 v192, v192, s60, v18
    v_fma_f32 v193, v193, s60, v18
    v_fma_f32 v194, v194, s60, v18
    v_fma_f32 v195, v195, s60, v18
    v_mul_f32 v192, v192, v112
    s_add_u32 m0, s55, 122880
    v_mfma_f32_32x32x16_bf16 v[160:175], v[28:31], a[28:31], v[160:175]
    ds_read_b64_tr_b16 v[60:61], v17 offset:1568
    ds_read_b64_tr_b16 v[62:63], v17 offset:1952
    buffer_load_dwordx4 v251, s[40:43], s54 offen offset:0 lds
    buffer_load_dwordx4 v252, s[40:43], s54 offen offset:1024 lds
    s_add_u32 s54, s54, 16384
    v_mul_f32 v193, v193, v113
    v_mul_f32 v194, v194, v114
    v_mul_f32 v195, v195, v115
    v_exp_f32 v192, v192
    v_mul_f32 v112, v112, v116
    v_exp_f32 v193, v193
    v_mul_f32 v113, v113, v117
    v_mfma_f32_32x32x16_bf16 v[176:191], v[32:35], a[28:31], v[176:191]
    ds_read_b64_tr_b16 v[64:65], v17 offset:1600
    ds_read_b64_tr_b16 v[66:67], v17 offset:1984
    v_exp_f32 v194, v194
    v_mul_f32 v114, v114, v118
    v_exp_f32 v195, v195
    v_mul_f32 v115, v115, v119
    v_add_f32 v192, 1.0, v192
    v_add_f32 v193, 1.0, v193
    v_rcp_f32 v192, v192
    s_waitcnt vmcnt(16)
    s_barrier
    s_waitcnt lgkmcnt(6)
    v_mfma_f32_32x32x16_bf16 v[144:159], v[40:43], a[32:35], v[144:159]
    ds_read_b64_tr_b16 v[24:25], v17 offset:3072
    ds_read_b64_tr_b16 v[26:27], v17 offset:3456
    v_add_f32 v194, 1.0, v194
    v_rcp_f32 v193, v193
    v_add_f32 v195, 1.0, v195
    v_rcp_f32 v194, v194
    v_mul_f32 v112, v112, v192
    v_rcp_f32 v195, v195
    v_mul_f32 v113, v113, v193
    v_mfma_f32_32x32x16_bf16 v[160:175], v[44:47], a[32:35], v[160:175]
    ds_read_b64_tr_b16 v[28:29], v17 offset:3104
    ds_read_b64_tr_b16 v[30:31], v17 offset:3488
    v_mul_f32 v114, v114, v194
    v_mul_f32 v115, v115, v195
    v_cvt_pk_bf16_f32 v200, v112, v113
    v_cvt_pk_bf16_f32 v201, v114, v115
    v_mul_f32 v196, v120, v120
    v_mul_f32 v197, v121, v121
    v_mul_f32 v198, v122, v122
    v_mfma_f32_32x32x16_bf16 v[176:191], v[48:51], a[32:35], v[176:191]
    ds_read_b64_tr_b16 v[32:33], v17 offset:3136
    ds_read_b64_tr_b16 v[34:35], v17 offset:3520
    v_mul_f32 v199, v123, v123
    v_fma_f32 v196, v196, s60, v18
    v_fma_f32 v197, v197, s60, v18
    v_fma_f32 v198, v198, s60, v18
    v_fma_f32 v199, v199, s60, v18
    v_mul_f32 v196, v196, v120
    v_mul_f32 v197, v197, v121
    s_waitcnt lgkmcnt(6)
    v_mfma_f32_32x32x16_bf16 v[144:159], v[56:59], a[36:39], v[144:159]
    ds_read_b64_tr_b16 v[40:41], v17 offset:4608
    ds_read_b64_tr_b16 v[42:43], v17 offset:4992
    v_mul_f32 v198, v198, v122
    v_mul_f32 v199, v199, v123
    v_exp_f32 v196, v196
    v_mul_f32 v120, v120, v124
    v_exp_f32 v197, v197
    v_mul_f32 v121, v121, v125
    v_exp_f32 v198, v198
    s_add_u32 m0, s55, 131072
    v_mfma_f32_32x32x16_bf16 v[160:175], v[60:63], a[36:39], v[160:175]
    ds_read_b64_tr_b16 v[44:45], v17 offset:4640
    ds_read_b64_tr_b16 v[46:47], v17 offset:5024
    buffer_load_dwordx4 v251, s[40:43], s54 offen offset:0 lds
    buffer_load_dwordx4 v252, s[40:43], s54 offen offset:1024 lds
    s_add_u32 s54, s54, 16384
    v_mul_f32 v122, v122, v126
    v_exp_f32 v199, v199
    v_mul_f32 v123, v123, v127
    v_add_f32 v196, 1.0, v196
    v_add_f32 v197, 1.0, v197
    v_rcp_f32 v196, v196
    v_add_f32 v198, 1.0, v198
    v_mfma_f32_32x32x16_bf16 v[176:191], v[64:67], a[36:39], v[176:191]
    ds_read_b64_tr_b16 v[48:49], v17 offset:4672
    ds_read_b64_tr_b16 v[50:51], v17 offset:5056
    v_rcp_f32 v197, v197
    v_add_f32 v199, 1.0, v199
    v_rcp_f32 v198, v198
    v_mul_f32 v120, v120, v196
    v_rcp_f32 v199, v199
    v_mul_f32 v121, v121, v197
    v_mul_f32 v122, v122, v198
    s_waitcnt lgkmcnt(6)
    v_mfma_f32_32x32x16_bf16 v[144:159], v[24:27], a[40:43], v[144:159]
    ds_read_b64_tr_b16 v[56:57], v17 offset:6144
    ds_read_b64_tr_b16 v[58:59], v17 offset:6528
    v_mul_f32 v123, v123, v199
    v_cvt_pk_bf16_f32 v202, v120, v121
    v_cvt_pk_bf16_f32 v203, v122, v123
    buffer_store_dwordx4 v[200:203], v253, s[12:15], s23 offen offset:2048 sc1
    v_mul_f32 v192, v128, v128
    v_mul_f32 v193, v129, v129
    v_mul_f32 v194, v130, v130
    v_mfma_f32_32x32x16_bf16 v[160:175], v[28:31], a[40:43], v[160:175]
    ds_read_b64_tr_b16 v[60:61], v17 offset:6176
    ds_read_b64_tr_b16 v[62:63], v17 offset:6560
    v_mul_f32 v195, v131, v131
    v_fma_f32 v192, v192, s60, v18
    v_fma_f32 v193, v193, s60, v18
    v_fma_f32 v194, v194, s60, v18
    v_fma_f32 v195, v195, s60, v18
    v_mul_f32 v192, v192, v128
    v_mul_f32 v193, v193, v129
    v_mfma_f32_32x32x16_bf16 v[176:191], v[32:35], a[40:43], v[176:191]
    ds_read_b64_tr_b16 v[64:65], v17 offset:6208
    ds_read_b64_tr_b16 v[66:67], v17 offset:6592
    v_mul_f32 v194, v194, v130
    v_mul_f32 v195, v195, v131
    v_exp_f32 v192, v192
    v_mul_f32 v128, v128, v132
    v_exp_f32 v193, v193
    v_mul_f32 v129, v129, v133
    v_exp_f32 v194, v194
    s_waitcnt lgkmcnt(6)
    v_mfma_f32_32x32x16_bf16 v[144:159], v[40:43], a[44:47], v[144:159]
    ds_read_b64_tr_b16 v[24:25], v17 offset:7680
    ds_read_b64_tr_b16 v[26:27], v17 offset:8064
    v_mul_f32 v130, v130, v134
    v_exp_f32 v195, v195
    v_mul_f32 v131, v131, v135
    v_add_f32 v192, 1.0, v192
    v_add_f32 v193, 1.0, v193
    v_rcp_f32 v192, v192
    v_add_f32 v194, 1.0, v194
    s_add_u32 m0, s55, 139264
    v_mfma_f32_32x32x16_bf16 v[160:175], v[44:47], a[44:47], v[160:175]
    ds_read_b64_tr_b16 v[28:29], v17 offset:7712
    ds_read_b64_tr_b16 v[30:31], v17 offset:8096
    buffer_load_dwordx4 v251, s[40:43], s54 offen offset:0 lds
    buffer_load_dwordx4 v252, s[40:43], s54 offen offset:1024 lds
    s_add_u32 s54, s54, 16384
    v_rcp_f32 v193, v193
    v_add_f32 v195, 1.0, v195
    v_rcp_f32 v194, v194
    v_mul_f32 v128, v128, v192
    v_rcp_f32 v195, v195
    v_mul_f32 v129, v129, v193
    v_mul_f32 v130, v130, v194
    v_mfma_f32_32x32x16_bf16 v[176:191], v[48:51], a[44:47], v[176:191]
    ds_read_b64_tr_b16 v[32:33], v17 offset:7744
    ds_read_b64_tr_b16 v[34:35], v17 offset:8128
    v_mul_f32 v131, v131, v195
    v_cvt_pk_bf16_f32 v204, v128, v129
    v_cvt_pk_bf16_f32 v205, v130, v131
    v_mul_f32 v196, v136, v136
    v_mul_f32 v197, v137, v137
    v_mul_f32 v198, v138, v138
    v_mul_f32 v199, v139, v139
    s_waitcnt lgkmcnt(6)
    v_mfma_f32_32x32x16_bf16 v[144:159], v[56:59], a[48:51], v[144:159]
    ds_read_b64_tr_b16 v[40:41], v17 offset:9216
    ds_read_b64_tr_b16 v[42:43], v17 offset:9600
    v_fma_f32 v196, v196, s60, v18
    v_fma_f32 v197, v197, s60, v18
    v_fma_f32 v198, v198, s60, v18
    v_fma_f32 v199, v199, s60, v18
    v_mul_f32 v196, v196, v136
    v_mul_f32 v197, v197, v137
    v_mul_f32 v198, v198, v138
    v_mfma_f32_32x32x16_bf16 v[160:175], v[60:63], a[48:51], v[160:175]
    ds_read_b64_tr_b16 v[44:45], v17 offset:9248
    ds_read_b64_tr_b16 v[46:47], v17 offset:9632
    v_mul_f32 v199, v199, v139
    v_exp_f32 v196, v196
    v_mul_f32 v136, v136, v140
    v_exp_f32 v197, v197
    v_mul_f32 v137, v137, v141
    v_exp_f32 v198, v198
    v_mul_f32 v138, v138, v142
    v_mfma_f32_32x32x16_bf16 v[176:191], v[64:67], a[48:51], v[176:191]
    ds_read_b64_tr_b16 v[48:49], v17 offset:9280
    ds_read_b64_tr_b16 v[50:51], v17 offset:9664
    v_exp_f32 v199, v199
    v_mul_f32 v139, v139, v143
    v_add_f32 v196, 1.0, v196
    v_add_f32 v197, 1.0, v197
    v_rcp_f32 v196, v196
    v_add_f32 v198, 1.0, v198
    v_rcp_f32 v197, v197
    s_waitcnt lgkmcnt(6)
    v_mfma_f32_32x32x16_bf16 v[144:159], v[24:27], a[52:55], v[144:159]
    ds_read_b64_tr_b16 v[56:57], v17 offset:10752
    ds_read_b64_tr_b16 v[58:59], v17 offset:11136
    v_add_f32 v199, 1.0, v199
    v_rcp_f32 v198, v198
    v_mul_f32 v136, v136, v196
    v_rcp_f32 v199, v199
    v_mul_f32 v137, v137, v197
    v_mul_f32 v138, v138, v198
    v_mul_f32 v139, v139, v199
    s_add_u32 m0, s55, 147456
    v_mfma_f32_32x32x16_bf16 v[160:175], v[28:31], a[52:55], v[160:175]
    ds_read_b64_tr_b16 v[60:61], v17 offset:10784
    ds_read_b64_tr_b16 v[62:63], v17 offset:11168
    buffer_load_dwordx4 v251, s[40:43], s54 offen offset:0 lds
    buffer_load_dwordx4 v252, s[40:43], s54 offen offset:1024 lds
    s_add_u32 s54, s54, 16384
    v_cvt_pk_bf16_f32 v206, v136, v137
    v_cvt_pk_bf16_f32 v207, v138, v139
    buffer_store_dwordx4 v[204:207], v253, s[12:15], s23 offen offset:3072 sc1
    v_mfma_f32_32x32x16_bf16 v[176:191], v[32:35], a[52:55], v[176:191]
    ds_read_b64_tr_b16 v[64:65], v17 offset:10816
    ds_read_b64_tr_b16 v[66:67], v17 offset:11200
    s_waitcnt lgkmcnt(6)
    v_mfma_f32_32x32x16_bf16 v[144:159], v[40:43], a[56:59], v[144:159]
    ds_read_b64_tr_b16 v[24:25], v17 offset:16384
    ds_read_b64_tr_b16 v[26:27], v17 offset:16768
    v_mfma_f32_32x32x16_bf16 v[160:175], v[44:47], a[56:59], v[160:175]
    ds_read_b64_tr_b16 v[28:29], v17 offset:16416
    ds_read_b64_tr_b16 v[30:31], v17 offset:16800
    v_mfma_f32_32x32x16_bf16 v[176:191], v[48:51], a[56:59], v[176:191]
    ds_read_b64_tr_b16 v[32:33], v17 offset:16448
    ds_read_b64_tr_b16 v[34:35], v17 offset:16832
    s_waitcnt lgkmcnt(6)
    v_mfma_f32_32x32x16_bf16 v[144:159], v[56:59], a[60:63], v[144:159]
    ds_read_b64_tr_b16 v[40:41], v17 offset:17920
    ds_read_b64_tr_b16 v[42:43], v17 offset:18304
    s_add_u32 m0, s55, 155648
    v_mfma_f32_32x32x16_bf16 v[160:175], v[60:63], a[60:63], v[160:175]
    ds_read_b64_tr_b16 v[44:45], v17 offset:17952
    ds_read_b64_tr_b16 v[46:47], v17 offset:18336
    buffer_load_dwordx4 v251, s[40:43], s54 offen offset:0 lds
    buffer_load_dwordx4 v252, s[40:43], s54 offen offset:1024 lds
    s_add_u32 s54, s54, 16384
    v_mfma_f32_32x32x16_bf16 v[176:191], v[64:67], a[60:63], v[176:191]
    ds_read_b64_tr_b16 v[48:49], v17 offset:17984
    ds_read_b64_tr_b16 v[50:51], v17 offset:18368
    s_waitcnt vmcnt(18)
    s_barrier
    s_waitcnt lgkmcnt(6)
    v_mfma_f32_32x32x16_bf16 v[144:159], v[24:27], a[64:67], v[144:159]
    ds_read_b64_tr_b16 v[56:57], v17 offset:19456
    ds_read_b64_tr_b16 v[58:59], v17 offset:19840
    v_mfma_f32_32x32x16_bf16 v[160:175], v[28:31], a[64:67], v[160:175]
    ds_read_b64_tr_b16 v[60:61], v17 offset:19488
    ds_read_b64_tr_b16 v[62:63], v17 offset:19872
    v_mfma_f32_32x32x16_bf16 v[176:191], v[32:35], a[64:67], v[176:191]
    ds_read_b64_tr_b16 v[64:65], v17 offset:19520
    ds_read_b64_tr_b16 v[66:67], v17 offset:19904
    s_waitcnt lgkmcnt(6)
    v_mfma_f32_32x32x16_bf16 v[144:159], v[40:43], a[68:71], v[144:159]
    ds_read_b64_tr_b16 v[24:25], v17 offset:20992
    ds_read_b64_tr_b16 v[26:27], v17 offset:21376
    s_add_u32 m0, s55, 0
    v_mfma_f32_32x32x16_bf16 v[160:175], v[44:47], a[68:71], v[160:175]
    ds_read_b64_tr_b16 v[28:29], v17 offset:21024
    ds_read_b64_tr_b16 v[30:31], v17 offset:21408
    buffer_load_dwordx4 v251, s[40:43], s54 offen offset:0 lds
    buffer_load_dwordx4 v252, s[40:43], s54 offen offset:1024 lds
    s_add_u32 s54, s54, 16384
    v_mfma_f32_32x32x16_bf16 v[176:191], v[48:51], a[68:71], v[176:191]
    ds_read_b64_tr_b16 v[32:33], v17 offset:21056
    ds_read_b64_tr_b16 v[34:35], v17 offset:21440
    s_waitcnt lgkmcnt(6)
    v_mfma_f32_32x32x16_bf16 v[144:159], v[56:59], a[72:75], v[144:159]
    ds_read_b64_tr_b16 v[40:41], v17 offset:22528
    ds_read_b64_tr_b16 v[42:43], v17 offset:22912
    v_mfma_f32_32x32x16_bf16 v[160:175], v[60:63], a[72:75], v[160:175]
    ds_read_b64_tr_b16 v[44:45], v17 offset:22560
    ds_read_b64_tr_b16 v[46:47], v17 offset:22944
    v_mfma_f32_32x32x16_bf16 v[176:191], v[64:67], a[72:75], v[176:191]
    ds_read_b64_tr_b16 v[48:49], v17 offset:22592
    ds_read_b64_tr_b16 v[50:51], v17 offset:22976
    s_waitcnt lgkmcnt(6)
    v_mfma_f32_32x32x16_bf16 v[144:159], v[24:27], a[76:79], v[144:159]
    ds_read_b64_tr_b16 v[56:57], v17 offset:24064
    ds_read_b64_tr_b16 v[58:59], v17 offset:24448
    s_add_u32 m0, s55, 8192
    v_mfma_f32_32x32x16_bf16 v[160:175], v[28:31], a[76:79], v[160:175]
    ds_read_b64_tr_b16 v[60:61], v17 offset:24096
    ds_read_b64_tr_b16 v[62:63], v17 offset:24480
    buffer_load_dwordx4 v251, s[40:43], s54 offen offset:0 lds
    buffer_load_dwordx4 v252, s[40:43], s54 offen offset:1024 lds
    s_add_u32 s54, s54, 16384
    v_mfma_f32_32x32x16_bf16 v[176:191], v[32:35], a[76:79], v[176:191]
    ds_read_b64_tr_b16 v[64:65], v17 offset:24128
    ds_read_b64_tr_b16 v[66:67], v17 offset:24512
    s_waitcnt vmcnt(6)
    s_barrier
    s_cmp_lg_u32 s16, 0
    s_cbranch_scc1 L_nf10
    v_mov_b32 v8, 1
    v_mov_b32 v9, 0
    s_mov_b64 exec, 1
    buffer_store_dword v8, v9, s[12:15], s21 offen sc1
    s_mov_b64 exec, -1
    L_nf10:
    s_waitcnt lgkmcnt(6)
    v_mfma_f32_32x32x16_bf16 v[144:159], v[40:43], a[80:83], v[144:159]
    ds_read_b64_tr_b16 v[24:25], v17 offset:25600
    ds_read_b64_tr_b16 v[26:27], v17 offset:25984
    v_mfma_f32_32x32x16_bf16 v[160:175], v[44:47], a[80:83], v[160:175]
    ds_read_b64_tr_b16 v[28:29], v17 offset:25632
    ds_read_b64_tr_b16 v[30:31], v17 offset:26016
    buffer_load_dwordx4 a[192:195], v251, s[40:43], s39 offen offset:0
    buffer_load_dwordx4 a[196:199], v252, s[40:43], s39 offen offset:1024
    s_add_u32 s39, s39, 16384
    v_mfma_f32_32x32x16_bf16 v[176:191], v[48:51], a[80:83], v[176:191]
    ds_read_b64_tr_b16 v[32:33], v17 offset:25664
    ds_read_b64_tr_b16 v[34:35], v17 offset:26048
    s_waitcnt lgkmcnt(6)
    v_mfma_f32_32x32x16_bf16 v[144:159], v[56:59], a[84:87], v[144:159]
    ds_read_b64_tr_b16 v[40:41], v17 offset:27136
    ds_read_b64_tr_b16 v[42:43], v17 offset:27520
    s_add_u32 m0, s55, 65536
    v_mfma_f32_32x32x16_bf16 v[160:175], v[60:63], a[84:87], v[160:175]
    ds_read_b64_tr_b16 v[44:45], v17 offset:27168
    ds_read_b64_tr_b16 v[46:47], v17 offset:27552
    buffer_load_dwordx4 v251, s[40:43], s54 offen offset:0 lds
    buffer_load_dwordx4 v252, s[40:43], s54 offen offset:1024 lds
    s_add_u32 s54, s54, 16384
    v_mfma_f32_32x32x16_bf16 v[176:191], v[64:67], a[84:87], v[176:191]
    ds_read_b64_tr_b16 v[48:49], v17 offset:27200
    ds_read_b64_tr_b16 v[50:51], v17 offset:27584
    s_waitcnt lgkmcnt(6)
    v_mfma_f32_32x32x16_bf16 v[144:159], v[24:27], a[88:91], v[144:159]
    ds_read_b64_tr_b16 v[56:57], v17 offset:32768
    ds_read_b64_tr_b16 v[58:59], v17 offset:33152
    v_mfma_f32_32x32x16_bf16 v[160:175], v[28:31], a[88:91], v[160:175]
    ds_read_b64_tr_b16 v[60:61], v17 offset:32800
    ds_read_b64_tr_b16 v[62:63], v17 offset:33184
    buffer_load_dwordx4 a[200:203], v251, s[40:43], s39 offen offset:0
    buffer_load_dwordx4 a[204:207], v252, s[40:43], s39 offen offset:1024
    s_add_u32 s39, s39, 16384
    v_mfma_f32_32x32x16_bf16 v[176:191], v[32:35], a[88:91], v[176:191]
    ds_read_b64_tr_b16 v[64:65], v17 offset:32832
    ds_read_b64_tr_b16 v[66:67], v17 offset:33216
    s_waitcnt lgkmcnt(6)
    v_mfma_f32_32x32x16_bf16 v[144:159], v[40:43], a[92:95], v[144:159]
    ds_read_b64_tr_b16 v[24:25], v17 offset:34304
    ds_read_b64_tr_b16 v[26:27], v17 offset:34688
    s_add_u32 m0, s55, 73728
    v_mfma_f32_32x32x16_bf16 v[160:175], v[44:47], a[92:95], v[160:175]
    ds_read_b64_tr_b16 v[28:29], v17 offset:34336
    ds_read_b64_tr_b16 v[30:31], v17 offset:34720
    buffer_load_dwordx4 v251, s[40:43], s54 offen offset:0 lds
    buffer_load_dwordx4 v252, s[40:43], s54 offen offset:1024 lds
    s_add_u32 s54, s54, 16384
    v_mfma_f32_32x32x16_bf16 v[176:191], v[48:51], a[92:95], v[176:191]
    ds_read_b64_tr_b16 v[32:33], v17 offset:34368
    ds_read_b64_tr_b16 v[34:35], v17 offset:34752
    s_barrier
    s_waitcnt lgkmcnt(6)
    v_mfma_f32_32x32x16_bf16 v[144:159], v[56:59], a[96:99], v[144:159]
    ds_read_b64_tr_b16 v[40:41], v17 offset:35840
    ds_read_b64_tr_b16 v[42:43], v17 offset:36224
    v_mfma_f32_32x32x16_bf16 v[160:175], v[60:63], a[96:99], v[160:175]
    ds_read_b64_tr_b16 v[44:45], v17 offset:35872
    ds_read_b64_tr_b16 v[46:47], v17 offset:36256
    buffer_load_dwordx4 a[208:211], v251, s[40:43], s39 offen offset:0
    buffer_load_dwordx4 a[212:215], v252, s[40:43], s39 offen offset:1024
    s_add_u32 s39, s39, 16384
    v_mfma_f32_32x32x16_bf16 v[176:191], v[64:67], a[96:99], v[176:191]
    ds_read_b64_tr_b16 v[48:49], v17 offset:35904
    ds_read_b64_tr_b16 v[50:51], v17 offset:36288
    s_waitcnt lgkmcnt(6)
    v_mfma_f32_32x32x16_bf16 v[144:159], v[24:27], a[100:103], v[144:159]
    ds_read_b64_tr_b16 v[56:57], v17 offset:37376
    ds_read_b64_tr_b16 v[58:59], v17 offset:37760
    s_add_u32 m0, s55, 16384
    v_mfma_f32_32x32x16_bf16 v[160:175], v[28:31], a[100:103], v[160:175]
    ds_read_b64_tr_b16 v[60:61], v17 offset:37408
    ds_read_b64_tr_b16 v[62:63], v17 offset:37792
    buffer_load_dwordx4 v251, s[40:43], s54 offen offset:0 lds
    buffer_load_dwordx4 v252, s[40:43], s54 offen offset:1024 lds
    s_add_u32 s54, s54, 16384
    v_mfma_f32_32x32x16_bf16 v[176:191], v[32:35], a[100:103], v[176:191]
    ds_read_b64_tr_b16 v[64:65], v17 offset:37440
    ds_read_b64_tr_b16 v[66:67], v17 offset:37824
    s_waitcnt lgkmcnt(6)
    v_mfma_f32_32x32x16_bf16 v[144:159], v[40:43], a[104:107], v[144:159]
    ds_read_b64_tr_b16 v[24:25], v17 offset:38912
    ds_read_b64_tr_b16 v[26:27], v17 offset:39296
    v_mfma_f32_32x32x16_bf16 v[160:175], v[44:47], a[104:107], v[160:175]
    ds_read_b64_tr_b16 v[28:29], v17 offset:38944
    ds_read_b64_tr_b16 v[30:31], v17 offset:39328
    buffer_load_dwordx4 a[216:219], v251, s[40:43], s39 offen offset:0
    buffer_load_dwordx4 a[220:223], v252, s[40:43], s39 offen offset:1024
    s_add_u32 s39, s39, 16384
    v_mfma_f32_32x32x16_bf16 v[176:191], v[48:51], a[104:107], v[176:191]
    ds_read_b64_tr_b16 v[32:33], v17 offset:38976
    ds_read_b64_tr_b16 v[34:35], v17 offset:39360
    s_waitcnt lgkmcnt(6)
    v_mfma_f32_32x32x16_bf16 v[144:159], v[56:59], a[108:111], v[144:159]
    ds_read_b64_tr_b16 v[40:41], v17 offset:40448
    ds_read_b64_tr_b16 v[42:43], v17 offset:40832
    s_add_u32 m0, s55, 24576
    v_mfma_f32_32x32x16_bf16 v[160:175], v[60:63], a[108:111], v[160:175]
    ds_read_b64_tr_b16 v[44:45], v17 offset:40480
    ds_read_b64_tr_b16 v[46:47], v17 offset:40864
    buffer_load_dwordx4 v251, s[40:43], s54 offen offset:0 lds
    buffer_load_dwordx4 v252, s[40:43], s54 offen offset:1024 lds
    s_add_u32 s54, s54, 16384
    v_mfma_f32_32x32x16_bf16 v[176:191], v[64:67], a[108:111], v[176:191]
    ds_read_b64_tr_b16 v[48:49], v17 offset:40512
    ds_read_b64_tr_b16 v[50:51], v17 offset:40896
    s_waitcnt lgkmcnt(6)
    v_mfma_f32_32x32x16_bf16 v[144:159], v[24:27], a[112:115], v[144:159]
    ds_read_b64_tr_b16 v[56:57], v17 offset:41984
    ds_read_b64_tr_b16 v[58:59], v17 offset:42368
    v_mfma_f32_32x32x16_bf16 v[160:175], v[28:31], a[112:115], v[160:175]
    ds_read_b64_tr_b16 v[60:61], v17 offset:42016
    ds_read_b64_tr_b16 v[62:63], v17 offset:42400
    v_mfma_f32_32x32x16_bf16 v[176:191], v[32:35], a[112:115], v[176:191]
    ds_read_b64_tr_b16 v[64:65], v17 offset:42048
    ds_read_b64_tr_b16 v[66:67], v17 offset:42432
    s_waitcnt lgkmcnt(6)
    v_mfma_f32_32x32x16_bf16 v[144:159], v[40:43], a[116:119], v[144:159]
    ds_read_b64_tr_b16 v[24:25], v17 offset:43520
    ds_read_b64_tr_b16 v[26:27], v17 offset:43904
    s_add_u32 m0, s55, 81920
    v_mfma_f32_32x32x16_bf16 v[160:175], v[44:47], a[116:119], v[160:175]
    ds_read_b64_tr_b16 v[28:29], v17 offset:43552
    ds_read_b64_tr_b16 v[30:31], v17 offset:43936
    buffer_load_dwordx4 v251, s[40:43], s54 offen offset:0 lds
    buffer_load_dwordx4 v252, s[40:43], s54 offen offset:1024 lds
    s_add_u32 s54, s54, 16384
    v_mfma_f32_32x32x16_bf16 v[176:191], v[48:51], a[116:119], v[176:191]
    ds_read_b64_tr_b16 v[32:33], v17 offset:43584
    ds_read_b64_tr_b16 v[34:35], v17 offset:43968
    s_waitcnt lgkmcnt(6)
    v_mfma_f32_32x32x16_bf16 v[144:159], v[56:59], a[120:123], v[144:159]
    v_mfma_f32_32x32x16_bf16 v[160:175], v[60:63], a[120:123], v[160:175]
    v_mfma_f32_32x32x16_bf16 v[176:191], v[64:67], a[120:123], v[176:191]
    s_waitcnt lgkmcnt(0)
    v_mfma_f32_32x32x16_bf16 v[144:159], v[24:27], a[124:127], v[144:159]
    s_add_u32 m0, s55, 90112
    v_mfma_f32_32x32x16_bf16 v[160:175], v[28:31], a[124:127], v[160:175]
    buffer_load_dwordx4 v251, s[40:43], s54 offen offset:0 lds
    buffer_load_dwordx4 v252, s[40:43], s54 offen offset:1024 lds
    s_add_u32 s54, s54, 16384
    v_mfma_f32_32x32x16_bf16 v[176:191], v[32:35], a[124:127], v[176:191]
    s_mul_i32 s3, s52, 229376
    s_add_u32 s3, s3, 6291456
    s_lshl_b32 s4, s16, 14
    s_add_u32 s17, s3, s4
    s_add_u32 s18, s17, 114688
    s_mul_i32 s4, s16, 12288
    s_add_u32 s3, s3, s4
    s_add_u32 s19, s3, 65536
    s_barrier
    buffer_load_dword v23, v22, s[12:15], s56 offen sc1
    v_pk_mul_f32 v[192:193], v[144:145], v[144:145]
    v_pk_mul_f32 v[194:195], v[146:147], v[146:147]
    v_pk_mul_f32 v[196:197], v[152:153], v[152:153]
    v_pk_mul_f32 v[198:199], v[154:155], v[154:155]
    v_pk_fma_f32 v[192:193], v[192:193], s[60:61], v[18:19]
    v_pk_fma_f32 v[194:195], v[194:195], s[60:61], v[18:19]
    v_pk_fma_f32 v[196:197], v[196:197], s[60:61], v[18:19]
    v_pk_fma_f32 v[198:199], v[198:199], s[60:61], v[18:19]
    v_pk_mul_f32 v[192:193], v[192:193], v[144:145]
    v_pk_mul_f32 v[194:195], v[194:195], v[146:147]
    v_pk_mul_f32 v[196:197], v[196:197], v[152:153]
    v_pk_mul_f32 v[198:199], v[198:199], v[154:155]
    v_exp_f32 v192, v192
    v_exp_f32 v193, v193
    v_pk_mul_f32 v[144:145], v[144:145], v[148:149]
    v_exp_f32 v194, v194
    v_exp_f32 v195, v195
    v_pk_mul_f32 v[146:147], v[146:147], v[150:151]
    v_exp_f32 v196, v196
    v_exp_f32 v197, v197
    v_pk_mul_f32 v[152:153], v[152:153], v[156:157]
    v_exp_f32 v198, v198
    v_exp_f32 v199, v199
    v_pk_mul_f32 v[154:155], v[154:155], v[158:159]
    v_pk_add_f32 v[192:193], v[192:193], v[20:21]
    v_pk_add_f32 v[194:195], v[194:195], v[20:21]
    v_pk_add_f32 v[196:197], v[196:197], v[20:21]
    v_pk_add_f32 v[198:199], v[198:199], v[20:21]
    v_rcp_f32 v192, v192
    v_rcp_f32 v193, v193
    v_rcp_f32 v194, v194
    v_rcp_f32 v195, v195
    v_rcp_f32 v196, v196
    v_rcp_f32 v197, v197
    v_rcp_f32 v198, v198
    v_rcp_f32 v199, v199
    v_pk_mul_f32 v[144:145], v[144:145], v[192:193]
    v_pk_mul_f32 v[146:147], v[146:147], v[194:195]
    v_pk_mul_f32 v[152:153], v[152:153], v[196:197]
    v_pk_mul_f32 v[154:155], v[154:155], v[198:199]
    v_cvt_pk_bf16_f32 v200, v144, v145
    v_cvt_pk_bf16_f32 v201, v146, v147
    v_cvt_pk_bf16_f32 v202, v152, v153
    v_cvt_pk_bf16_f32 v203, v154, v155
    buffer_store_dwordx4 v[200:203], v253, s[12:15], s24 offen offset:0 sc1
    s_waitcnt vmcnt(1)
    v_cmp_eq_u32 vcc, 1, v23
    s_nop 0
    s_cmp_eq_u64 vcc, exec
    s_cbranch_scc1 L_ok11
    s_mov_b32 s3, 0
    L_poll12:
    s_add_u32 s3, s3, 1
    s_cmp_gt_u32 s3, 0x80000
    s_cbranch_scc1 L_pe13
    buffer_load_dword v8, v22, s[12:15], s56 offen sc1
    s_waitcnt vmcnt(0)
    v_cmp_eq_u32 vcc, 1, v8
    s_nop 0
    s_cmp_eq_u64 vcc, exec
    s_cbranch_scc0 L_poll12
    L_pe13:
    L_ok11:
    buffer_load_dwordx4 a[0:3], v253, s[12:15], s17 offen offset:0 sc1
    buffer_load_dwordx4 a[4:7], v253, s[12:15], s18 offen offset:0 sc1
    v_pk_mul_f32 v[192:193], v[160:161], v[160:161]
    v_pk_mul_f32 v[194:195], v[162:163], v[162:163]
    v_pk_mul_f32 v[196:197], v[168:169], v[168:169]
    v_pk_mul_f32 v[198:199], v[170:171], v[170:171]
    v_pk_fma_f32 v[192:193], v[192:193], s[60:61], v[18:19]
    v_pk_fma_f32 v[194:195], v[194:195], s[60:61], v[18:19]
    v_pk_fma_f32 v[196:197], v[196:197], s[60:61], v[18:19]
    v_pk_fma_f32 v[198:199], v[198:199], s[60:61], v[18:19]
    v_pk_mul_f32 v[192:193], v[192:193], v[160:161]
    v_pk_mul_f32 v[194:195], v[194:195], v[162:163]
    v_pk_mul_f32 v[196:197], v[196:197], v[168:169]
    v_pk_mul_f32 v[198:199], v[198:199], v[170:171]
    v_exp_f32 v192, v192
    v_exp_f32 v193, v193
    v_pk_mul_f32 v[160:161], v[160:161], v[164:165]
    v_exp_f32 v194, v194
    buffer_load_dwordx4 a[8:11], v253, s[12:15], s17 offen offset:1024 sc1
    buffer_load_dwordx4 a[12:15], v253, s[12:15], s18 offen offset:1024 sc1
    v_exp_f32 v195, v195
    v_pk_mul_f32 v[162:163], v[162:163], v[166:167]
    v_exp_f32 v196, v196
    v_exp_f32 v197, v197
    v_pk_mul_f32 v[168:169], v[168:169], v[172:173]
    v_exp_f32 v198, v198
    v_exp_f32 v199, v199
    v_pk_mul_f32 v[170:171], v[170:171], v[174:175]
    v_pk_add_f32 v[192:193], v[192:193], v[20:21]
    v_pk_add_f32 v[194:195], v[194:195], v[20:21]
    v_pk_add_f32 v[196:197], v[196:197], v[20:21]
    v_pk_add_f32 v[198:199], v[198:199], v[20:21]
    v_rcp_f32 v192, v192
    v_rcp_f32 v193, v193
    v_rcp_f32 v194, v194
    v_rcp_f32 v195, v195
    buffer_load_dwordx4 a[16:19], v253, s[12:15], s17 offen offset:2048 sc1
    buffer_load_dwordx4 a[20:23], v253, s[12:15], s18 offen offset:2048 sc1
    v_rcp_f32 v196, v196
    v_rcp_f32 v197, v197
    v_rcp_f32 v198, v198
    v_rcp_f32 v199, v199
    v_pk_mul_f32 v[160:161], v[160:161], v[192:193]
    v_pk_mul_f32 v[162:163], v[162:163], v[194:195]
    v_pk_mul_f32 v[168:169], v[168:169], v[196:197]
    v_pk_mul_f32 v[170:171], v[170:171], v[198:199]
    v_cvt_pk_bf16_f32 v204, v160, v161
    v_cvt_pk_bf16_f32 v205, v162, v163
    v_cvt_pk_bf16_f32 v206, v168, v169
    v_cvt_pk_bf16_f32 v207, v170, v171
    buffer_store_dwordx4 v[204:207], v253, s[12:15], s24 offen offset:1024 sc1
    v_pk_mul_f32 v[192:193], v[176:177], v[176:177]
    v_pk_mul_f32 v[194:195], v[178:179], v[178:179]
    v_pk_mul_f32 v[196:197], v[184:185], v[184:185]
    buffer_load_dwordx4 a[24:27], v253, s[12:15], s17 offen offset:3072 sc1
    buffer_load_dwordx4 a[28:31], v253, s[12:15], s18 offen offset:3072 sc1
    s_add_u32 s17, s17, 4096
    s_add_u32 s18, s17, 114688
    v_pk_mul_f32 v[198:199], v[186:187], v[186:187]
    v_pk_fma_f32 v[192:193], v[192:193], s[60:61], v[18:19]
    v_pk_fma_f32 v[194:195], v[194:195], s[60:61], v[18:19]
    v_pk_fma_f32 v[196:197], v[196:197], s[60:61], v[18:19]
    v_pk_fma_f32 v[198:199], v[198:199], s[60:61], v[18:19]
    v_pk_mul_f32 v[192:193], v[192:193], v[176:177]
    v_pk_mul_f32 v[194:195], v[194:195], v[178:179]
    v_pk_mul_f32 v[196:197], v[196:197], v[184:185]
    v_pk_mul_f32 v[198:199], v[198:199], v[186:187]
    v_exp_f32 v192, v192
    v_exp_f32 v193, v193
    v_pk_mul_f32 v[176:177], v[176:177], v[180:181]
    v_exp_f32 v194, v194
    v_exp_f32 v195, v195
    v_pk_mul_f32 v[178:179], v[178:179], v[182:183]
    v_exp_f32 v196, v196
    buffer_load_dwordx4 a[32:35], v253, s[12:15], s17 offen offset:0 sc1
    buffer_load_dwordx4 a[36:39], v253, s[12:15], s18 offen offset:0 sc1
    v_exp_f32 v197, v197
    v_pk_mul_f32 v[184:185], v[184:185], v[188:189]
    v_exp_f32 v198, v198
    v_exp_f32 v199, v199
    v_pk_mul_f32 v[186:187], v[186:187], v[190:191]
    v_pk_add_f32 v[192:193], v[192:193], v[20:21]
    v_pk_add_f32 v[194:195], v[194:195], v[20:21]
    v_pk_add_f32 v[196:197], v[196:197], v[20:21]
    v_pk_add_f32 v[198:199], v[198:199], v[20:21]
    v_rcp_f32 v192, v192
    v_rcp_f32 v193, v193
    v_rcp_f32 v194, v194
    v_rcp_f32 v195, v195
    v_rcp_f32 v196, v196
    v_rcp_f32 v197, v197
    v_rcp_f32 v198, v198
    buffer_load_dwordx4 a[40:43], v253, s[12:15], s17 offen offset:1024 sc1
    buffer_load_dwordx4 a[44:47], v253, s[12:15], s18 offen offset:1024 sc1
    v_rcp_f32 v199, v199
    v_pk_mul_f32 v[176:177], v[176:177], v[192:193]
    v_pk_mul_f32 v[178:179], v[178:179], v[194:195]
    v_pk_mul_f32 v[184:185], v[184:185], v[196:197]
    v_pk_mul_f32 v[186:187], v[186:187], v[198:199]
    v_cvt_pk_bf16_f32 v200, v176, v177
    v_cvt_pk_bf16_f32 v201, v178, v179
    v_cvt_pk_bf16_f32 v202, v184, v185
    v_cvt_pk_bf16_f32 v203, v186, v187
    buffer_store_dwordx4 v[200:203], v253, s[12:15], s24 offen offset:2048 sc1
    ds_read_b64_tr_b16 v[24:25], v210 offset:49152
    ds_read_b64_tr_b16 v[26:27], v210 offset:50176
    ds_read_b64_tr_b16 v[28:29], v211 offset:49152
    ds_read_b64_tr_b16 v[30:31], v211 offset:50176
    buffer_load_dwordx4 a[48:51], v253, s[12:15], s17 offen offset:2048 sc1
    buffer_load_dwordx4 a[52:55], v253, s[12:15], s18 offen offset:2048 sc1
    buffer_load_dwordx4 a[56:59], v253, s[12:15], s17 offen offset:3072 sc1
    buffer_load_dwordx4 a[60:63], v253, s[12:15], s18 offen offset:3072 sc1
    s_add_u32 s17, s17, 4096
    s_add_u32 s18, s17, 114688
    buffer_load_dwordx4 a[64:67], v253, s[12:15], s17 offen offset:0 sc1
    buffer_load_dwordx4 a[68:71], v253, s[12:15], s18 offen offset:0 sc1
    s_waitcnt vmcnt(18)
    ds_read_b64_tr_b16 v[32:33], v210 offset:57344
    ds_read_b64_tr_b16 v[34:35], v210 offset:58368
    ds_read_b64_tr_b16 v[36:37], v211 offset:57344
    ds_read_b64_tr_b16 v[38:39], v211 offset:58368
    s_waitcnt lgkmcnt(4)
    v_mfma_f32_32x32x16_bf16 v[40:55], v[24:27], a[0:3], 0
    buffer_load_dwordx4 a[72:75], v253, s[12:15], s17 offen offset:1024 sc1
    buffer_load_dwordx4 a[76:79], v253, s[12:15], s18 offen offset:1024 sc1
    v_mfma_f32_32x32x16_bf16 v[56:71], v[28:31], a[0:3], 0
    v_mfma_f32_32x32x16_bf16 v[72:87], v[24:27], a[4:7], 0
    ds_write_b128 v217, a[128:131] offset:32768
    v_mfma_f32_32x32x16_bf16 v[88:103], v[28:31], a[4:7], 0
    ds_write_b128 v217, a[132:135] offset:33792
    s_waitcnt vmcnt(8)
    s_barrier
    s_cmp_lg_u32 s16, 0
    s_cbranch_scc1 L_nf14
    v_mov_b32 v8, 1
    v_mov_b32 v9, 0
    s_mov_b64 exec, 1
    buffer_store_dword v8, v9, s[12:15], s22 offen sc1
    s_mov_b64 exec, -1
    L_nf14:
    ds_read_b64_tr_b16 v[24:25], v212 offset:49152
    ds_read_b64_tr_b16 v[26:27], v212 offset:50176
    ds_read_b64_tr_b16 v[28:29], v213 offset:49152
    ds_read_b64_tr_b16 v[30:31], v213 offset:50176
    s_waitcnt lgkmcnt(4)
    v_mfma_f32_32x32x16_bf16 v[40:55], v[32:35], a[8:11], v[40:55]
    buffer_load_dwordx4 a[80:83], v253, s[12:15], s17 offen offset:2048 sc1
    buffer_load_dwordx4 a[84:87], v253, s[12:15], s18 offen offset:2048 sc1
    v_mfma_f32_32x32x16_bf16 v[56:71], v[36:39], a[8:11], v[56:71]
    v_mfma_f32_32x32x16_bf16 v[72:87], v[32:35], a[12:15], v[72:87]
    ds_write_b128 v217, a[136:139] offset:40960
    v_mfma_f32_32x32x16_bf16 v[88:103], v[36:39], a[12:15], v[88:103]
    ds_write_b128 v217, a[140:143] offset:41984
    ds_read_b64_tr_b16 v[32:33], v212 offset:57344
    ds_read_b64_tr_b16 v[34:35], v212 offset:58368
    ds_read_b64_tr_b16 v[36:37], v213 offset:57344
    ds_read_b64_tr_b16 v[38:39], v213 offset:58368
    s_waitcnt lgkmcnt(4)
    v_mfma_f32_32x32x16_bf16 v[40:55], v[24:27], a[16:19], v[40:55]
    buffer_load_dwordx4 a[88:91], v253, s[12:15], s17 offen offset:3072 sc1
    buffer_load_dwordx4 a[92:95], v253, s[12:15], s18 offen offset:3072 sc1
    s_add_u32 s17, s17, 4096
    s_add_u32 s18, s17, 114688
    v_mfma_f32_32x32x16_bf16 v[56:71], v[28:31], a[16:19], v[56:71]
    v_mfma_f32_32x32x16_bf16 v[72:87], v[24:27], a[20:23], v[72:87]
    ds_write_b128 v218, a[144:147] offset:32768
    v_mfma_f32_32x32x16_bf16 v[88:103], v[28:31], a[20:23], v[88:103]
    ds_write_b128 v218, a[148:151] offset:33792
    ds_read_b64_tr_b16 v[24:25], v214 offset:0
    ds_read_b64_tr_b16 v[26:27], v214 offset:1024
    ds_read_b64_tr_b16 v[28:29], v215 offset:0
    ds_read_b64_tr_b16 v[30:31], v215 offset:1024
    s_waitcnt lgkmcnt(4)
    v_mfma_f32_32x32x16_bf16 v[40:55], v[32:35], a[24:27], v[40:55]
    buffer_load_dwordx4 a[96:99], v253, s[12:15], s17 offen offset:0 sc1
    buffer_load_dwordx4 a[100:103], v253, s[12:15], s18 offen offset:0 sc1
    v_mfma_f32_32x32x16_bf16 v[56:71], v[36:39], a[24:27], v[56:71]
    v_mfma_f32_32x32x16_bf16 v[72:87], v[32:35], a[28:31], v[72:87]
    ds_write_b128 v218, a[152:155] offset:40960
    v_mfma_f32_32x32x16_bf16 v[88:103], v[36:39], a[28:31], v[88:103]
    ds_write_b128 v218, a[156:159] offset:41984
    ds_read_b64_tr_b16 v[32:33], v214 offset:8192
    ds_read_b64_tr_b16 v[34:35], v214 offset:9216
    ds_read_b64_tr_b16 v[36:37], v215 offset:8192
    ds_read_b64_tr_b16 v[38:39], v215 offset:9216
    s_waitcnt lgkmcnt(4)
    v_mfma_f32_32x32x16_bf16 v[40:55], v[24:27], a[32:35], v[40:55]
    buffer_load_dwordx4 a[104:107], v253, s[12:15], s17 offen offset:1024 sc1
    buffer_load_dwordx4 a[108:111], v253, s[12:15], s18 offen offset:1024 sc1
    v_mfma_f32_32x32x16_bf16 v[56:71], v[28:31], a[32:35], v[56:71]
    v_mfma_f32_32x32x16_bf16 v[72:87], v[24:27], a[36:39], v[72:87]
    ds_write_b128 v217, a[160:163] offset:49152
    v_mfma_f32_32x32x16_bf16 v[88:103], v[28:31], a[36:39], v[88:103]
    ds_write_b128 v217, a[164:167] offset:50176
    ds_read_b64_tr_b16 v[24:25], v214 offset:16384
    ds_read_b64_tr_b16 v[26:27], v214 offset:17408
    ds_read_b64_tr_b16 v[28:29], v215 offset:16384
    ds_read_b64_tr_b16 v[30:31], v215 offset:17408
    s_waitcnt lgkmcnt(4)
    v_mfma_f32_32x32x16_bf16 v[40:55], v[32:35], a[40:43], v[40:55]
    buffer_load_dwordx4 a[112:115], v253, s[12:15], s17 offen offset:2048 sc1
    buffer_load_dwordx4 a[116:119], v253, s[12:15], s18 offen offset:2048 sc1
    v_mfma_f32_32x32x16_bf16 v[56:71], v[36:39], a[40:43], v[56:71]
    v_mfma_f32_32x32x16_bf16 v[72:87], v[32:35], a[44:47], v[72:87]
    ds_write_b128 v217, a[168:171] offset:57344
    v_mfma_f32_32x32x16_bf16 v[88:103], v[36:39], a[44:47], v[88:103]
    ds_write_b128 v217, a[172:175] offset:58368
    s_waitcnt vmcnt(16)
    ds_read_b64_tr_b16 v[32:33], v214 offset:24576
    ds_read_b64_tr_b16 v[34:35], v214 offset:25600
    ds_read_b64_tr_b16 v[36:37], v215 offset:24576
    ds_read_b64_tr_b16 v[38:39], v215 offset:25600
    s_waitcnt lgkmcnt(4)
    v_mfma_f32_32x32x16_bf16 v[40:55], v[24:27], a[48:51], v[40:55]
    buffer_load_dwordx4 a[120:123], v253, s[12:15], s17 offen offset:3072 sc1
    buffer_load_dwordx4 a[124:127], v253, s[12:15], s18 offen offset:3072 sc1
    s_mov_b32 s17, s19
    s_add_u32 s18, s17, 114688
    v_mfma_f32_32x32x16_bf16 v[56:71], v[28:31], a[48:51], v[56:71]
    v_mfma_f32_32x32x16_bf16 v[72:87], v[24:27], a[52:55], v[72:87]
    ds_write_b128 v218, a[176:179] offset:49152
    v_mfma_f32_32x32x16_bf16 v[88:103], v[28:31], a[52:55], v[88:103]
    ds_write_b128 v218, a[180:183] offset:50176
    s_waitcnt vmcnt(16)
    ds_read_b64_tr_b16 v[24:25], v210 offset:0
    ds_read_b64_tr_b16 v[26:27], v210 offset:1024
    ds_read_b64_tr_b16 v[28:29], v211 offset:0
    ds_read_b64_tr_b16 v[30:31], v211 offset:1024
    s_waitcnt lgkmcnt(4)
    v_mfma_f32_32x32x16_bf16 v[40:55], v[32:35], a[56:59], v[40:55]
    v_mfma_f32_32x32x16_bf16 v[56:71], v[36:39], a[56:59], v[56:71]
    v_mfma_f32_32x32x16_bf16 v[72:87], v[32:35], a[60:63], v[72:87]
    ds_write_b128 v218, a[184:187] offset:57344
    v_mfma_f32_32x32x16_bf16 v[88:103], v[36:39], a[60:63], v[88:103]
    ds_write_b128 v218, a[188:191] offset:58368
    buffer_load_dword v23, v22, s[12:15], s57 offen sc1
    s_waitcnt vmcnt(15)
    ds_read_b64_tr_b16 v[32:33], v210 offset:8192
    ds_read_b64_tr_b16 v[34:35], v210 offset:9216
    ds_read_b64_tr_b16 v[36:37], v211 offset:8192
    ds_read_b64_tr_b16 v[38:39], v211 offset:9216
    s_waitcnt lgkmcnt(4)
    v_mfma_f32_32x32x16_bf16 v[40:55], v[24:27], a[64:67], v[40:55]
    v_mfma_f32_32x32x16_bf16 v[56:71], v[28:31], a[64:67], v[56:71]
    v_mfma_f32_32x32x16_bf16 v[72:87], v[24:27], a[68:71], v[72:87]
    ds_write_b128 v219, a[192:195] offset:0
    v_mfma_f32_32x32x16_bf16 v[88:103], v[28:31], a[68:71], v[88:103]
    ds_write_b128 v219, a[196:199] offset:1024
    s_waitcnt vmcnt(13)
    ds_read_b64_tr_b16 v[24:25], v212 offset:0
    ds_read_b64_tr_b16 v[26:27], v212 offset:1024
    ds_read_b64_tr_b16 v[28:29], v213 offset:0
    ds_read_b64_tr_b16 v[30:31], v213 offset:1024
    s_waitcnt lgkmcnt(4)
    s_waitcnt vmcnt(0)
    v_cmp_eq_u32 vcc, 1, v23
    s_nop 0
    s_cmp_eq_u64 vcc, exec
    s_cbranch_scc1 L_ok15
    s_mov_b32 s3, 0
    L_poll16:
    s_add_u32 s3, s3, 1
    s_cmp_gt_u32 s3, 0x80000
    s_cbranch_scc1 L_pe17
    buffer_load_dword v8, v22, s[12:15], s57 offen sc1
    s_waitcnt vmcnt(0)
    v_cmp_eq_u32 vcc, 1, v8
    s_nop 0
    s_cmp_eq_u64 vcc, exec
    s_cbranch_scc0 L_poll16
    L_pe17:
    L_ok15:
    v_mfma_f32_32x32x16_bf16 v[40:55], v[32:35], a[72:75], v[40:55]
    buffer_load_dwordx4 a[0:3], v253, s[12:15], s17 offen offset:0 sc1
    buffer_load_dwordx4 a[4:7], v253, s[12:15], s18 offen offset:0 sc1
    v_mfma_f32_32x32x16_bf16 v[56:71], v[36:39], a[72:75], v[56:71]
    v_mfma_f32_32x32x16_bf16 v[72:87], v[32:35], a[76:79], v[72:87]
    ds_write_b128 v219, a[200:203] offset:8192
    v_mfma_f32_32x32x16_bf16 v[88:103], v[36:39], a[76:79], v[88:103]
    ds_write_b128 v219, a[204:207] offset:9216
    ds_read_b64_tr_b16 v[32:33], v212 offset:8192
    ds_read_b64_tr_b16 v[34:35], v212 offset:9216
    ds_read_b64_tr_b16 v[36:37], v213 offset:8192
    ds_read_b64_tr_b16 v[38:39], v213 offset:9216
    s_waitcnt lgkmcnt(4)
    v_mfma_f32_32x32x16_bf16 v[40:55], v[24:27], a[80:83], v[40:55]
    buffer_load_dwordx4 a[8:11], v253, s[12:15], s17 offen offset:1024 sc1
    buffer_load_dwordx4 a[12:15], v253, s[12:15], s18 offen offset:1024 sc1
    v_mfma_f32_32x32x16_bf16 v[56:71], v[28:31], a[80:83], v[56:71]
    v_mfma_f32_32x32x16_bf16 v[72:87], v[24:27], a[84:87], v[72:87]
    ds_write_b128 v219, a[208:211] offset:16384
    v_mfma_f32_32x32x16_bf16 v[88:103], v[28:31], a[84:87], v[88:103]
    ds_write_b128 v219, a[212:215] offset:17408
    ds_read_b64_tr_b16 v[24:25], v210 offset:16384
    ds_read_b64_tr_b16 v[26:27], v210 offset:17408
    ds_read_b64_tr_b16 v[28:29], v211 offset:16384
    ds_read_b64_tr_b16 v[30:31], v211 offset:17408
    s_waitcnt lgkmcnt(4)
    v_mfma_f32_32x32x16_bf16 v[40:55], v[32:35], a[88:91], v[40:55]
    buffer_load_dwordx4 a[16:19], v253, s[12:15], s17 offen offset:2048 sc1
    buffer_load_dwordx4 a[20:23], v253, s[12:15], s18 offen offset:2048 sc1
    v_mfma_f32_32x32x16_bf16 v[56:71], v[36:39], a[88:91], v[56:71]
    v_mfma_f32_32x32x16_bf16 v[72:87], v[32:35], a[92:95], v[72:87]
    ds_write_b128 v219, a[216:219] offset:24576
    v_mfma_f32_32x32x16_bf16 v[88:103], v[36:39], a[92:95], v[88:103]
    ds_write_b128 v219, a[220:223] offset:25600
    ds_read_b64_tr_b16 v[32:33], v210 offset:24576
    ds_read_b64_tr_b16 v[34:35], v210 offset:25600
    ds_read_b64_tr_b16 v[36:37], v211 offset:24576
    ds_read_b64_tr_b16 v[38:39], v211 offset:25600
    s_waitcnt lgkmcnt(4)
    v_mfma_f32_32x32x16_bf16 v[40:55], v[24:27], a[96:99], v[40:55]
    buffer_load_dwordx4 a[24:27], v253, s[12:15], s17 offen offset:3072 sc1
    buffer_load_dwordx4 a[28:31], v253, s[12:15], s18 offen offset:3072 sc1
    s_add_u32 s17, s17, 4096
    s_add_u32 s18, s17, 114688
    v_mfma_f32_32x32x16_bf16 v[56:71], v[28:31], a[96:99], v[56:71]
    v_mfma_f32_32x32x16_bf16 v[72:87], v[24:27], a[100:103], v[72:87]
    v_mfma_f32_32x32x16_bf16 v[88:103], v[28:31], a[100:103], v[88:103]
    ds_read_b64_tr_b16 v[24:25], v212 offset:16384
    ds_read_b64_tr_b16 v[26:27], v212 offset:17408
    ds_read_b64_tr_b16 v[28:29], v213 offset:16384
    ds_read_b64_tr_b16 v[30:31], v213 offset:17408
    s_waitcnt lgkmcnt(4)
    v_mfma_f32_32x32x16_bf16 v[40:55], v[32:35], a[104:107], v[40:55]
    buffer_load_dwordx4 a[32:35], v253, s[12:15], s17 offen offset:0 sc1
    buffer_load_dwordx4 a[36:39], v253, s[12:15], s18 offen offset:0 sc1
    v_mfma_f32_32x32x16_bf16 v[56:71], v[36:39], a[104:107], v[56:71]
    v_mfma_f32_32x32x16_bf16 v[72:87], v[32:35], a[108:111], v[72:87]
    v_mfma_f32_32x32x16_bf16 v[88:103], v[36:39], a[108:111], v[88:103]
    ds_read_b64_tr_b16 v[32:33], v212 offset:24576
    ds_read_b64_tr_b16 v[34:35], v212 offset:25600
    ds_read_b64_tr_b16 v[36:37], v213 offset:24576
    ds_read_b64_tr_b16 v[38:39], v213 offset:25600
    s_waitcnt lgkmcnt(4)
    v_mfma_f32_32x32x16_bf16 v[40:55], v[24:27], a[112:115], v[40:55]
    buffer_load_dwordx4 a[40:43], v253, s[12:15], s17 offen offset:1024 sc1
    buffer_load_dwordx4 a[44:47], v253, s[12:15], s18 offen offset:1024 sc1
    v_mfma_f32_32x32x16_bf16 v[56:71], v[28:31], a[112:115], v[56:71]
    v_mfma_f32_32x32x16_bf16 v[72:87], v[24:27], a[116:119], v[72:87]
    v_mfma_f32_32x32x16_bf16 v[88:103], v[28:31], a[116:119], v[88:103]
    ds_read_b64_tr_b16 v[24:25], v210 offset:32768
    ds_read_b64_tr_b16 v[26:27], v210 offset:33792
    ds_read_b64_tr_b16 v[28:29], v211 offset:32768
    ds_read_b64_tr_b16 v[30:31], v211 offset:33792
    s_waitcnt lgkmcnt(4)
    v_mfma_f32_32x32x16_bf16 v[40:55], v[32:35], a[120:123], v[40:55]
    buffer_load_dwordx4 a[48:51], v253, s[12:15], s17 offen offset:2048 sc1
    buffer_load_dwordx4 a[52:55], v253, s[12:15], s18 offen offset:2048 sc1
    v_mfma_f32_32x32x16_bf16 v[56:71], v[36:39], a[120:123], v[56:71]
    v_mfma_f32_32x32x16_bf16 v[72:87], v[32:35], a[124:127], v[72:87]
    v_mfma_f32_32x32x16_bf16 v[88:103], v[36:39], a[124:127], v[88:103]
    s_waitcnt vmcnt(12)
    ds_read_b64_tr_b16 v[32:33], v210 offset:40960
    ds_read_b64_tr_b16 v[34:35], v210 offset:41984
    ds_read_b64_tr_b16 v[36:37], v211 offset:40960
    ds_read_b64_tr_b16 v[38:39], v211 offset:41984
    s_waitcnt lgkmcnt(4)
    v_mfma_f32_32x32x16_bf16 v[40:55], v[24:27], a[0:3], v[40:55]
    buffer_load_dwordx4 a[56:59], v253, s[12:15], s17 offen offset:3072 sc1
    buffer_load_dwordx4 a[60:63], v253, s[12:15], s18 offen offset:3072 sc1
    s_add_u32 s17, s17, 4096
    s_add_u32 s18, s17, 114688
    v_mfma_f32_32x32x16_bf16 v[56:71], v[28:31], a[0:3], v[56:71]
    v_mfma_f32_32x32x16_bf16 v[72:87], v[24:27], a[4:7], v[72:87]
    v_mfma_f32_32x32x16_bf16 v[88:103], v[28:31], a[4:7], v[88:103]
    s_waitcnt vmcnt(12)
    ds_read_b64_tr_b16 v[24:25], v212 offset:32768
    ds_read_b64_tr_b16 v[26:27], v212 offset:33792
    ds_read_b64_tr_b16 v[28:29], v213 offset:32768
    ds_read_b64_tr_b16 v[30:31], v213 offset:33792
    s_waitcnt lgkmcnt(4)
    v_mfma_f32_32x32x16_bf16 v[40:55], v[32:35], a[8:11], v[40:55]
    buffer_load_dwordx4 a[64:67], v253, s[12:15], s17 offen offset:0 sc1
    buffer_load_dwordx4 a[68:71], v253, s[12:15], s18 offen offset:0 sc1
    v_mfma_f32_32x32x16_bf16 v[56:71], v[36:39], a[8:11], v[56:71]
    v_mfma_f32_32x32x16_bf16 v[72:87], v[32:35], a[12:15], v[72:87]
    v_mfma_f32_32x32x16_bf16 v[88:103], v[36:39], a[12:15], v[88:103]
    s_waitcnt vmcnt(12)
    ds_read_b64_tr_b16 v[32:33], v212 offset:40960
    ds_read_b64_tr_b16 v[34:35], v212 offset:41984
    ds_read_b64_tr_b16 v[36:37], v213 offset:40960
    ds_read_b64_tr_b16 v[38:39], v213 offset:41984
    s_waitcnt lgkmcnt(4)
    v_mfma_f32_32x32x16_bf16 v[40:55], v[24:27], a[16:19], v[40:55]
    buffer_load_dwordx4 a[72:75], v253, s[12:15], s17 offen offset:1024 sc1
    buffer_load_dwordx4 a[76:79], v253, s[12:15], s18 offen offset:1024 sc1
    v_mfma_f32_32x32x16_bf16 v[56:71], v[28:31], a[16:19], v[56:71]
    v_mfma_f32_32x32x16_bf16 v[72:87], v[24:27], a[20:23], v[72:87]
    v_mfma_f32_32x32x16_bf16 v[88:103], v[28:31], a[20:23], v[88:103]
    s_waitcnt vmcnt(12)
    ds_read_b64_tr_b16 v[24:25], v210 offset:49152
    ds_read_b64_tr_b16 v[26:27], v210 offset:50176
    ds_read_b64_tr_b16 v[28:29], v211 offset:49152
    ds_read_b64_tr_b16 v[30:31], v211 offset:50176
    s_waitcnt lgkmcnt(4)
    v_mfma_f32_32x32x16_bf16 v[40:55], v[32:35], a[24:27], v[40:55]
    buffer_load_dwordx4 a[80:83], v253, s[12:15], s17 offen offset:2048 sc1
    buffer_load_dwordx4 a[84:87], v253, s[12:15], s18 offen offset:2048 sc1
    v_mfma_f32_32x32x16_bf16 v[56:71], v[36:39], a[24:27], v[56:71]
    v_mfma_f32_32x32x16_bf16 v[72:87], v[32:35], a[28:31], v[72:87]
    v_mfma_f32_32x32x16_bf16 v[88:103], v[36:39], a[28:31], v[88:103]
    s_waitcnt vmcnt(12)
    ds_read_b64_tr_b16 v[32:33], v210 offset:57344
    ds_read_b64_tr_b16 v[34:35], v210 offset:58368
    ds_read_b64_tr_b16 v[36:37], v211 offset:57344
    ds_read_b64_tr_b16 v[38:39], v211 offset:58368
    s_waitcnt lgkmcnt(4)
    v_mfma_f32_32x32x16_bf16 v[40:55], v[24:27], a[32:35], v[40:55]
    buffer_load_dwordx4 a[88:91], v253, s[12:15], s17 offen offset:3072 sc1
    buffer_load_dwordx4 a[92:95], v253, s[12:15], s18 offen offset:3072 sc1
    v_mfma_f32_32x32x16_bf16 v[56:71], v[28:31], a[32:35], v[56:71]
    v_mfma_f32_32x32x16_bf16 v[72:87], v[24:27], a[36:39], v[72:87]
    v_mfma_f32_32x32x16_bf16 v[88:103], v[28:31], a[36:39], v[88:103]
    s_waitcnt vmcnt(12)
    ds_read_b64_tr_b16 v[24:25], v212 offset:49152
    ds_read_b64_tr_b16 v[26:27], v212 offset:50176
    ds_read_b64_tr_b16 v[28:29], v213 offset:49152
    ds_read_b64_tr_b16 v[30:31], v213 offset:50176
    s_waitcnt lgkmcnt(4)
    v_mfma_f32_32x32x16_bf16 v[40:55], v[32:35], a[40:43], v[40:55]
    buffer_load_dwordx4 v[12:15], v208, s[12:15], s59 offen sc1
    buffer_load_dwordx4 v[16:19], v209, s[12:15], s59 offen sc1
    v_bfe_u32 v5, v2, 3, 2
    v_lshlrev_b32 v5, 13, v5
    v_mfma_f32_32x32x16_bf16 v[56:71], v[36:39], a[40:43], v[56:71]
    v_and_b32 v6, 7, v2
    v_lshl_add_u32 v5, v6, 8, v5
    v_add_u32 v5, s55, v5
    v_mfma_f32_32x32x16_bf16 v[72:87], v[32:35], a[44:47], v[72:87]
    v_lshrrev_b32 v7, 5, v2
    v_xor_b32 v6, v6, v7
    v_mfma_f32_32x32x16_bf16 v[88:103], v[36:39], a[44:47], v[88:103]
    v_lshl_add_u32 v220, v6, 4, v5
    v_xor_b32 v221, 32, v220
    v_xor_b32 v222, 64, v220
    s_waitcnt vmcnt(12)
    ds_read_b64_tr_b16 v[32:33], v212 offset:57344
    ds_read_b64_tr_b16 v[34:35], v212 offset:58368
    ds_read_b64_tr_b16 v[36:37], v213 offset:57344
    ds_read_b64_tr_b16 v[38:39], v213 offset:58368
    s_waitcnt lgkmcnt(4)
    v_mfma_f32_32x32x16_bf16 v[40:55], v[24:27], a[48:51], v[40:55]
    v_xor_b32 v223, 0x60, v220
    v_lshlrev_b32 v5, 2, s55
    v_lshrrev_b32 v6, 3, v2
    v_mfma_f32_32x32x16_bf16 v[56:71], v[28:31], a[48:51], v[56:71]
    v_lshl_add_u32 v5, v6, 8, v5
    v_and_b32 v7, 7, v2
    v_lshlrev_b32 v7, 1, v7
    v_mfma_f32_32x32x16_bf16 v[72:87], v[24:27], a[52:55], v[72:87]
    v_xor_b32 v6, v6, v7
    v_lshl_add_u32 v224, v6, 4, v5
    v_xor_b32 v225, 16, v224
    v_mfma_f32_32x32x16_bf16 v[88:103], v[28:31], a[52:55], v[88:103]
    s_waitcnt vmcnt(10)
    ds_read_b64_tr_b16 v[120:121], v214 offset:0
    ds_read_b64_tr_b16 v[122:123], v214 offset:1024
    ds_read_b64_tr_b16 v[124:125], v215 offset:0
    ds_read_b64_tr_b16 v[126:127], v215 offset:1024
    s_waitcnt lgkmcnt(4)
    v_mfma_f32_32x32x16_bf16 v[40:55], v[32:35], a[56:59], v[40:55]
    ds_read_b64_tr_b16 v[128:129], v214 offset:8192
    ds_read_b64_tr_b16 v[130:131], v214 offset:9216
    ds_read_b64_tr_b16 v[132:133], v215 offset:8192
    ds_read_b64_tr_b16 v[134:135], v215 offset:9216
    v_mfma_f32_32x32x16_bf16 v[56:71], v[36:39], a[56:59], v[56:71]
    ds_read_b64_tr_b16 v[136:137], v214 offset:16384
    ds_read_b64_tr_b16 v[138:139], v214 offset:17408
    ds_read_b64_tr_b16 v[140:141], v215 offset:16384
    ds_read_b64_tr_b16 v[142:143], v215 offset:17408
    v_mfma_f32_32x32x16_bf16 v[72:87], v[32:35], a[60:63], v[72:87]
    ds_read_b64_tr_b16 v[144:145], v214 offset:24576
    ds_read_b64_tr_b16 v[146:147], v214 offset:25600
    ds_read_b64_tr_b16 v[148:149], v215 offset:24576
    ds_read_b64_tr_b16 v[150:151], v215 offset:25600
    v_mfma_f32_32x32x16_bf16 v[88:103], v[36:39], a[60:63], v[88:103]
    s_waitcnt vmcnt(8)
    s_waitcnt lgkmcnt(12)
    v_mfma_f32_32x32x16_bf16 v[40:55], v[120:123], a[64:67], v[40:55]
    v_mfma_f32_32x32x16_bf16 v[56:71], v[124:127], a[64:67], v[56:71]
    s_waitcnt vmcnt(6)
    s_waitcnt lgkmcnt(8)
    v_mfma_f32_32x32x16_bf16 v[40:55], v[128:131], a[72:75], v[40:55]
    v_mfma_f32_32x32x16_bf16 v[56:71], v[132:135], a[72:75], v[56:71]
    s_waitcnt vmcnt(4)
    s_waitcnt lgkmcnt(4)
    v_mfma_f32_32x32x16_bf16 v[40:55], v[136:139], a[80:83], v[40:55]
    v_mfma_f32_32x32x16_bf16 v[56:71], v[140:143], a[80:83], v[56:71]
    s_waitcnt vmcnt(0)
    s_waitcnt lgkmcnt(0)
    v_mfma_f32_32x32x16_bf16 v[40:55], v[144:147], a[88:91], v[40:55]
    v_mfma_f32_32x32x16_bf16 v[56:71], v[148:151], a[88:91], v[56:71]
    v_mfma_f32_32x32x16_bf16 v[72:87], v[120:123], a[68:71], v[72:87]
    v_lshlrev_b32 v152, 16, v12
    v_and_b32 v153, 0xffff0000, v12
    v_lshlrev_b32 v154, 16, v13
    v_and_b32 v155, 0xffff0000, v13
    v_lshlrev_b32 v156, 16, v14
    v_and_b32 v157, 0xffff0000, v14
    v_mfma_f32_32x32x16_bf16 v[88:103], v[124:127], a[68:71], v[88:103]
    s_nop 2
    ds_write_b128 v220, v[40:43] offset:0
    ds_write_b128 v221, v[44:47] offset:0
    v_lshlrev_b32 v158, 16, v15
    v_and_b32 v159, 0xffff0000, v15
    v_mfma_f32_32x32x16_bf16 v[72:87], v[128:131], a[76:79], v[72:87]
    ds_write_b128 v222, v[48:51] offset:0
    ds_write_b128 v223, v[52:55] offset:0
    v_lshlrev_b32 v160, 16, v16
    v_and_b32 v161, 0xffff0000, v16
    v_mfma_f32_32x32x16_bf16 v[88:103], v[132:135], a[76:79], v[88:103]
    ds_write_b128 v220, v[56:59] offset:128
    ds_write_b128 v221, v[60:63] offset:128
    v_lshlrev_b32 v162, 16, v17
    v_and_b32 v163, 0xffff0000, v17
    v_mfma_f32_32x32x16_bf16 v[72:87], v[136:139], a[84:87], v[72:87]
    ds_write_b128 v222, v[64:67] offset:128
    ds_write_b128 v223, v[68:71] offset:128
    v_lshlrev_b32 v164, 16, v18
    v_and_b32 v165, 0xffff0000, v18
    v_mfma_f32_32x32x16_bf16 v[88:103], v[140:143], a[84:87], v[88:103]
    v_lshlrev_b32 v166, 16, v19
    v_and_b32 v167, 0xffff0000, v19
    s_waitcnt lgkmcnt(0)
    s_barrier
    v_mfma_f32_32x32x16_bf16 v[72:87], v[144:147], a[92:95], v[72:87]
    ds_read_b128 v[168:171], v224 offset:0
    ds_read_b128 v[172:175], v225 offset:0
    ds_read_b128 v[176:179], v224 offset:2048
    ds_read_b128 v[180:183], v225 offset:2048
    v_mfma_f32_32x32x16_bf16 v[88:103], v[148:151], a[92:95], v[88:103]
    ds_read_b128 v[184:187], v224 offset:4096
    ds_read_b128 v[188:191], v225 offset:4096
    ds_read_b128 v[192:195], v224 offset:6144
    ds_read_b128 v[196:199], v225 offset:6144
    s_waitcnt lgkmcnt(6)
    v_pk_add_f32 v[152:153], v[152:153], v[168:169]
    v_pk_add_f32 v[154:155], v[154:155], v[170:171]
    v_pk_add_f32 v[156:157], v[156:157], v[172:173]
    v_pk_add_f32 v[158:159], v[158:159], v[174:175]
    ds_write_b128 v220, v[72:75] offset:32768
    ds_write_b128 v221, v[76:79] offset:32768
    s_waitcnt lgkmcnt(6)
    v_pk_add_f32 v[152:153], v[152:153], v[176:177]
    v_pk_add_f32 v[154:155], v[154:155], v[178:179]
    v_pk_add_f32 v[156:157], v[156:157], v[180:181]
    v_pk_add_f32 v[158:159], v[158:159], v[182:183]
    ds_write_b128 v222, v[80:83] offset:32768
    ds_write_b128 v223, v[84:87] offset:32768
    s_waitcnt lgkmcnt(6)
    v_pk_add_f32 v[152:153], v[152:153], v[184:185]
    v_pk_add_f32 v[154:155], v[154:155], v[186:187]
    v_pk_add_f32 v[156:157], v[156:157], v[188:189]
    v_pk_add_f32 v[158:159], v[158:159], v[190:191]
    ds_write_b128 v220, v[88:91] offset:32896
    ds_write_b128 v221, v[92:95] offset:32896
    s_waitcnt lgkmcnt(6)
    v_pk_add_f32 v[152:153], v[152:153], v[192:193]
    v_pk_add_f32 v[154:155], v[154:155], v[194:195]
    v_pk_add_f32 v[156:157], v[156:157], v[196:197]
    v_pk_add_f32 v[158:159], v[158:159], v[198:199]
    ds_write_b128 v222, v[96:99] offset:32896
    ds_write_b128 v223, v[100:103] offset:32896
    v_cvt_pk_bf16_f32 v12, v152, v153
    v_cvt_pk_bf16_f32 v13, v154, v155
    v_cvt_pk_bf16_f32 v14, v156, v157
    v_cvt_pk_bf16_f32 v15, v158, v159
    buffer_store_dwordx4 v[12:15], v208, s[44:47], s58 offen sc1
    s_waitcnt lgkmcnt(0)
    s_barrier
    ds_read_b128 v[168:171], v224 offset:32768
    ds_read_b128 v[172:175], v225 offset:32768
    ds_read_b128 v[176:179], v224 offset:34816
    ds_read_b128 v[180:183], v225 offset:34816
    ds_read_b128 v[184:187], v224 offset:36864
    ds_read_b128 v[188:191], v225 offset:36864
    ds_read_b128 v[192:195], v224 offset:38912
    ds_read_b128 v[196:199], v225 offset:38912
    s_waitcnt lgkmcnt(6)
    v_pk_add_f32 v[160:161], v[160:161], v[168:169]
    v_pk_add_f32 v[162:163], v[162:163], v[170:171]
    v_pk_add_f32 v[164:165], v[164:165], v[172:173]
    v_pk_add_f32 v[166:167], v[166:167], v[174:175]
    s_waitcnt lgkmcnt(4)
    v_pk_add_f32 v[160:161], v[160:161], v[176:177]
    v_pk_add_f32 v[162:163], v[162:163], v[178:179]
    v_pk_add_f32 v[164:165], v[164:165], v[180:181]
    v_pk_add_f32 v[166:167], v[166:167], v[182:183]
    s_waitcnt lgkmcnt(2)
    v_pk_add_f32 v[160:161], v[160:161], v[184:185]
    v_pk_add_f32 v[162:163], v[162:163], v[186:187]
    v_pk_add_f32 v[164:165], v[164:165], v[188:189]
    v_pk_add_f32 v[166:167], v[166:167], v[190:191]
    s_waitcnt lgkmcnt(0)
    v_pk_add_f32 v[160:161], v[160:161], v[192:193]
    v_pk_add_f32 v[162:163], v[162:163], v[194:195]
    v_pk_add_f32 v[164:165], v[164:165], v[196:197]
    v_pk_add_f32 v[166:167], v[166:167], v[198:199]
    v_cvt_pk_bf16_f32 v16, v160, v161
    v_cvt_pk_bf16_f32 v17, v162, v163
    v_cvt_pk_bf16_f32 v18, v164, v165
    v_cvt_pk_bf16_f32 v19, v166, v167
    buffer_store_dwordx4 v[16:19], v209, s[44:47], s58 offen sc1
    L_end:
    s_endpgm
.section .rodata,"a"
.p2align 6
.amdhsa_kernel sequential_preLN__spectral_fnet__geglu_ffn__prompt_kernel
  .amdhsa_next_free_vgpr 512
  .amdhsa_next_free_sgpr 100
  .amdhsa_accum_offset 256
  .amdhsa_group_segment_fixed_size 0
  .amdhsa_kernarg_size 96
  .amdhsa_user_sgpr_count 2
  .amdhsa_user_sgpr_kernarg_segment_ptr 1
  .amdhsa_system_sgpr_workgroup_id_x 1
  .amdhsa_float_denorm_mode_32 3
.end_amdhsa_kernel
```
